```python
import torch

def _softmax(x, axis=-1):
    return torch.softmax(x, dim=axis)

def _gelu(x):
    return torch.nn.functional.gelu(x, approximate='tanh')

def _silu(x):
    return torch.nn.functional.silu(x)

def _sigmoid(x):
    return torch.sigmoid(x)

def _layernorm(x, axis=-1, eps=1e-05):
    m = x.mean(dim=axis, keepdim=True)
    v = x.var(dim=axis, keepdim=True, unbiased=False)
    return (x - m) / torch.sqrt(v + eps)

def _scatter_add(tgt, idx, src, axis=0):
    return tgt.clone().index_add_(axis, idx, src)

def _segment_sum(src, seg, n):
    out = torch.zeros((n,) + src.shape[1:], dtype=src.dtype)
    return out.index_add_(0, seg, src)

def _pad(x, pw):
    flat = tuple((v for pair in reversed(pw) for v in pair))
    return torch.nn.functional.pad(x, flat)
kernel_name = 'adaLN_cond__spectral_gfnet__dense_activation_mish__prompt'

def setup_inputs():

    _w = lambda a: (lambda t: t.to(torch.bfloat16) if t.is_floating_point() else t)(torch.as_tensor(a))

    def _A_setup():
        B, S, D = (1, 2048, 512)
        Df = D // 2 + 1
        return {'x': _w((lambda *s: torch.randn(*s, dtype=torch.bfloat16) * 0.05)(B, S, D)), 'w_r': _w((lambda *s: torch.randn(*s, dtype=torch.bfloat16) * 1.6)(S, Df) * 0.02), 'w_i': _w((lambda *s: torch.randn(*s, dtype=torch.bfloat16) * 1.6)(S, Df) * 0.02)}
    _A_in = _A_setup()

    def _B_setup():
        B, S, D, F = (1, 2048, 512, 1376)
        return {'x': _w((lambda *s: torch.randn(*s, dtype=torch.bfloat16) * 0.05)(B, S, D)), 'w1': _w((lambda *s: torch.randn(*s, dtype=torch.bfloat16) * 0.8)(D, F) * D ** (-0.5)), 'b1': _w((lambda *s: torch.randn(*s, dtype=torch.bfloat16) * 0.4)(F)), 'w2': _w((lambda *s: torch.randn(*s, dtype=torch.bfloat16) * 0.2)(F, D) * F ** (-0.5))}
    _B_in = _B_setup()
    return {'A_x': _A_in['x'], 'A_w_r': _A_in['w_r'], 'A_w_i': _A_in['w_i'], 'B_x': _B_in['x'], 'B_w1': _B_in['w1'], 'B_b1': _B_in['b1'], 'B_w2': _B_in['w2'], 'c': _w((lambda *s: torch.randn(*s, dtype=torch.bfloat16) * 0.2)(1, 512) * 8.0), 'w_mod': _w((lambda *s: torch.randn(*s, dtype=torch.bfloat16) * 0.2)(512, 6 * 512) * 512 ** (-0.5) * 8.0)}

def reference(A_x, A_w_r, A_w_i, B_x, B_w1, B_b1, B_w2, c, w_mod):

    def _A_ref(x, w_r, w_i):
        B, S, D = x.shape
        X = (lambda x, axes=(-2, -1): torch.fft.rfft2(x.float(), dim=axes))(x, axes=(-2, -1))
        W = w_r + 1j * w_i
        X = X * W
        y = (lambda x, s, axes=(-2, -1): torch.fft.irfft2(x, s=s, dim=axes).to(torch.bfloat16))(X, (S, D), axes=(-2, -1))
        return y

    def _B_ref(x, w1, b1, w2):
        h = torch.einsum('bsd,df->bsf', x, w1) + b1
        sp = torch.log1p(torch.exp(-torch.abs(h))) + torch.where(h > 0, h, torch.zeros_like(h))
        act = h * torch.tanh(sp)
        return torch.einsum('bsf,fd->bsd', act, w2)
    x = A_x
    mod = (_silu(c) @ w_mod).reshape(c.shape[0], 6, 1, -1)
    sa, ca, ga, sb, cb, gb = (mod[:, 0].clone(), mod[:, 1].clone(), mod[:, 2].clone(), mod[:, 3].clone(), mod[:, 4].clone(), mod[:, 5].clone())
    h = _layernorm(x, axis=-1) * (1 + ca) + sa
    x = x + ga * _A_ref(h, A_w_r, A_w_i)
    h = _layernorm(x, axis=-1) * (1 + cb) + sb
    x = x + gb * _B_ref(h, B_w1, B_b1, B_w2)
    return x
```

```asm
; @launch grid=(256,1,1) block=(256,1,1) lds=163840
.amdgcn_target "amdgcn-amd-amdhsa--gfx950"
.text
.globl adaLN_cond__spectral_gfnet__dense_activation_mish__prompt_kernel
.p2align 8
.type adaLN_cond__spectral_gfnet__dense_activation_mish__prompt_kernel,@function
adaLN_cond__spectral_gfnet__dense_activation_mish__prompt_kernel:
    s_cmp_ge_u32 s2, 256
    s_cbranch_scc1 L_exit_adaLN_cond__spectral_gfnet__dense_activation_mish__prompt_kernel
    s_load_dwordx16 s[56:71], s[0:1], 0
    s_load_dwordx8 s[72:79], s[0:1], 64
    s_memrealtime s[24:25]
    v_lshrrev_b32 v1, 6, v0
    v_and_b32 v0, 63, v0
    v_readfirstlane_b32 s3, v1
    v_lshlrev_b32 v2, 4, v0
    v_and_b32 v3, 31, v0
    v_lshrrev_b32 v4, 5, v0
    v_and_b32 v5, 15, v0
    v_lshrrev_b32 v6, 4, v0
    s_and_b32 s20, s2, 3
    s_lshr_b32 s21, s2, 2
    s_and_b32 s20, s2, 1
    s_lshl_b32 s20, s20, 1
    s_bfe_u32 s22, s2, 0x10003
    s_or_b32 s20, s20, s22
    s_bfe_u32 s21, s2, 0x20001
    s_lshr_b32 s22, s2, 4
    s_lshl_b32 s22, s22, 2
    s_or_b32 s21, s21, s22
    s_getpc_b64 s[16:17]
L_pc_m:
    s_add_u32 s16, s16, L_tables-L_pc_m
    s_addc_u32 s17, s17, 0
    s_sub_u32 s4, s16, L_tables-adaLN_cond__spectral_gfnet__dense_activation_mish__prompt_kernel
    s_subb_u32 s5, s17, 0
    s_lshr_b32 s22, s2, 3
    s_lshl_b32 s22, s22, 2
    s_add_u32 s22, s22, s3
    v_lshl_add_u32 v7, v0, 7, s22
    v_min_u32 v7, (L_tables_end-adaLN_cond__spectral_gfnet__dense_activation_mish__prompt_kernel)/128-1, v7
    v_lshlrev_b32 v7, 7, v7
    s_mov_b64 exec, 7
    global_load_dword v179, v7, s[4:5]
    s_mov_b64 exec, -1
    s_lshl_b32 s22, s2, 2
    s_add_u32 s22, s22, s3
    s_lshl_b32 s22, s22, 8
    s_add_u32 s22, s22, L_stab-L_tables
    s_add_u32 s18, s16, s22
    s_addc_u32 s19, s17, 0
    s_lshl_b32 s28, s3, 19
    s_lshl_b32 s29, s21, 10
    s_add_u32 s28, s28, s29
    s_mul_i32 s29, s3, 8256
    s_waitcnt lgkmcnt(0)
    s_mov_b32 s36, s76
    s_mov_b32 s37, s77
    s_mov_b32 s38, 0x100
    s_mov_b32 s39, 0x20000
    s_lshr_b32 s22, s2, 3
    s_or_b32 s22, s22, s3
    s_cmp_eq_u32 s22, 0
    s_cselect_b32 s22, 0, 2147483392
    s_or_b32 s24, s24, 0x80000000
    v_mov_b32 v8, s24
    v_mov_b32 v9, 0
    s_mov_b64 exec, 1
    buffer_atomic_cmpswap v[8:9], v2, s[36:39], s22 offen sc1
    s_mov_b64 exec, -1
    s_mov_b32 s12, s78
    s_mov_b32 s13, s79
    s_mov_b32 s14, 0x2000000
    s_mov_b32 s15, 0x20000
    v_lshlrev_b32 v57, 2, v0
    v_mov_b32 v56, 0
    s_cmp_lt_u32 s2, 64
    s_cbranch_scc1 L_a1
L_a1_back:
    s_cmp_lt_u32 s2, 64
    s_cbranch_scc1 L_c1
    s_mov_b32 s4, s64
    s_mov_b32 s5, s65
    s_mov_b32 s6, 0x158000
    s_mov_b32 s7, 0x20000
    s_sub_u32 s23, s2, 64
    s_mul_i32 s95, s23, 21846
    s_lshr_b32 s95, s95, 16
    s_mul_i32 s24, s95, 3
    s_sub_u32 s23, s23, s24
    s_mul_i32 s23, s23, 120
    v_lshl_add_u32 v7, s3, 6, v0
    v_cmp_gt_u32 vcc, 120, v7
    v_add_u32 v7, s23, v7
    s_movk_i32 s23, 344
    v_cmp_gt_u32 s[24:25], s23, v7
    s_lshr_b32 s22, s95, 2
    s_bfe_u32 s23, s95, 0x10001
    s_lshl_b32 s23, s23, 8
    s_add_u32 s22, s22, s23
    s_and_b32 s23, s95, 1
    s_lshl_b32 s23, s23, 6
    s_add_u32 s22, s22, s23
    s_mul_i32 s22, s22, 2752
    s_and_b64 vcc, vcc, s[24:25]
    v_mov_b32 v12, 2147483392
    v_lshlrev_b32 v8, 3, v7
    v_cndmask_b32 v8, v12, v8, vcc
    s_add_u32 s23, s22, 0
    buffer_load_dwordx2 v[16:17], v8, s[4:7], s23 offen nt
    s_add_u32 s23, s22, 44032
    buffer_load_dwordx2 v[18:19], v8, s[4:7], s23 offen nt
    s_add_u32 s23, s22, 88064
    buffer_load_dwordx2 v[20:21], v8, s[4:7], s23 offen nt
    s_add_u32 s23, s22, 132096
    buffer_load_dwordx2 v[22:23], v8, s[4:7], s23 offen nt
    s_add_u32 s23, s22, 352256
    buffer_load_dwordx2 v[24:25], v8, s[4:7], s23 offen nt
    s_add_u32 s23, s22, 396288
    buffer_load_dwordx2 v[26:27], v8, s[4:7], s23 offen nt
    s_add_u32 s23, s22, 440320
    buffer_load_dwordx2 v[28:29], v8, s[4:7], s23 offen nt
    s_add_u32 s23, s22, 484352
    buffer_load_dwordx2 v[30:31], v8, s[4:7], s23 offen nt
    v_lshrrev_b32 v10, 3, v7
    v_lshlrev_b32 v10, 15, v10
    v_and_b32 v11, 7, v7
    v_lshl_add_u32 v56, v11, 4, v10
    v_cndmask_b32 v56, v12, v56, vcc
L_c1:
    s_mov_b32 s8, s70
    s_mov_b32 s9, s71
    s_mov_b32 s10, 0x400
    s_mov_b32 s11, 0x20000
    s_and_b32 s22, s2, 3
    s_lshl_b32 s22, s22, 8
    v_lshl_add_u32 v7, s3, 6, v0
    v_lshrrev_b32 v8, 3, v7
    v_lshlrev_b32 v10, 1, v8
    buffer_load_ushort v108, v10, s[8:11], s22 offen offset:0
    buffer_load_ushort v109, v10, s[8:11], s22 offen offset:64
    buffer_load_ushort v110, v10, s[8:11], s22 offen offset:128
    buffer_load_ushort v111, v10, s[8:11], s22 offen offset:192
    s_load_dwordx16 s[40:55], s[18:19], 0
    s_load_dword s30, s[18:19], 128
    s_load_dword s1, s[18:19], 64
    s_load_dword s94, s[18:19], 192
    s_mov_b32 s32, s56
    s_mov_b32 s33, s57
    s_mov_b32 s34, 0x200000
    s_mov_b32 s35, 0x20000
    s_mov_b64 s[96:97], s[66:67]
    s_mov_b64 s[98:99], s[68:69]
    s_mov_b64 s[100:101], s[74:75]
    v_lshrrev_b32 v9, 3, v3
    v_lshl_add_u32 v9, s3, 2, v9
    v_bfe_u32 v10, v3, 1, 2
    v_lshl_add_u32 v10, s20, 2, v10
    v_and_b32 v11, 1, v3
    v_mul_u32_u24 v12, v9, v10
    v_lshl_add_u32 v12, v11, 7, v12
    v_lshlrev_b32 v13, 4, v10
    v_lshl_or_b32 v14, v10, 1, v11
    v_cmp_eq_u32 vcc, 1, v14
    s_nop 1
    v_cndmask_b32 v12, v12, 0, vcc
    v_mov_b32 v14, 256
    v_cndmask_b32 v13, v13, v14, vcc
    v_lshlrev_b32 v14, 2, v4
    v_mad_u32_u24 v12, v13, v14, v12
    v_cvt_f32_u32 v12, v12
    v_cvt_f32_u32 v13, v13
    v_mul_f32 v12, 0x3b000000, v12
    v_mul_f32 v13, 0x3b000000, v13
    v_mov_b32 v15, 0
    v_mov_b32 v96, v12
    v_fmamk_f32 v97, v13, 0x3f800000, v12
    v_fmamk_f32 v98, v13, 0x40000000, v12
    v_fmamk_f32 v99, v13, 0x40400000, v12
    v_cos_f32 v96, v96
    v_cos_f32 v97, v97
    v_cos_f32 v98, v98
    v_cos_f32 v99, v99
    v_cvt_pk_bf16_f32 v112, v96, v97
    v_cvt_pk_bf16_f32 v113, v98, v99
    v_fmamk_f32 v96, v13, 0x41000000, v12
    v_fmamk_f32 v97, v13, 0x41100000, v12
    v_fmamk_f32 v98, v13, 0x41200000, v12
    v_fmamk_f32 v99, v13, 0x41300000, v12
    v_cos_f32 v96, v96
    v_cos_f32 v97, v97
    v_cos_f32 v98, v98
    buffer_load_dword v181, v15, s[36:39], 0 offen sc1
    v_cos_f32 v99, v99
    v_cvt_pk_bf16_f32 v114, v96, v97
    v_cvt_pk_bf16_f32 v115, v98, v99
    v_fmamk_f32 v96, v13, 0x41800000, v12
    v_fmamk_f32 v97, v13, 0x41880000, v12
    v_fmamk_f32 v98, v13, 0x41900000, v12
    v_fmamk_f32 v99, v13, 0x41980000, v12
    v_cos_f32 v96, v96
    s_mov_b32 m0, s29
    s_nop 0
    buffer_load_dwordx4 v2, s[32:35], s28 offen nt lds
    s_add_u32 s28, s28, 65536
    s_add_u32 s29, s29, 1032
    v_cos_f32 v97, v97
    v_cos_f32 v98, v98
    v_cos_f32 v99, v99
    v_cvt_pk_bf16_f32 v116, v96, v97
    v_cvt_pk_bf16_f32 v117, v98, v99
    v_fmamk_f32 v96, v13, 0x41c00000, v12
    v_fmamk_f32 v97, v13, 0x41c80000, v12
    s_mov_b32 m0, s29
    s_nop 0
    buffer_load_dwordx4 v2, s[32:35], s28 offen nt lds
    s_add_u32 s28, s28, 65536
    s_add_u32 s29, s29, 1032
    v_fmamk_f32 v98, v13, 0x41d00000, v12
    v_fmamk_f32 v99, v13, 0x41d80000, v12
    v_cos_f32 v96, v96
    v_cos_f32 v97, v97
    v_cos_f32 v98, v98
    v_cos_f32 v99, v99
    s_mov_b32 m0, s29
    s_nop 0
    buffer_load_dwordx4 v2, s[32:35], s28 offen nt lds
    s_add_u32 s28, s28, 65536
    s_add_u32 s29, s29, 1032
    v_cvt_pk_bf16_f32 v118, v96, v97
    v_cvt_pk_bf16_f32 v119, v98, v99
    s_mov_b32 s26, 0xff
    s_mov_b32 s27, s26
    v_cndmask_b32 v128, 0, v112, s[26:27]
    v_cndmask_b32 v129, 0, v113, s[26:27]
    v_cndmask_b32 v130, 0, v114, s[26:27]
    v_cndmask_b32 v131, 0, v115, s[26:27]
    v_cndmask_b32 v132, 0, v116, s[26:27]
    v_cndmask_b32 v133, 0, v117, s[26:27]
    v_cndmask_b32 v134, 0, v118, s[26:27]
    v_cndmask_b32 v135, 0, v119, s[26:27]
    s_mov_b32 m0, s29
    s_nop 0
    buffer_load_dwordx4 v2, s[32:35], s28 offen nt lds
    s_add_u32 s28, s28, 65536
    s_add_u32 s29, s29, 1032
    s_mov_b32 s26, 0xff00
    s_mov_b32 s27, s26
    v_cndmask_b32 v136, 0, v112, s[26:27]
    v_cndmask_b32 v137, 0, v113, s[26:27]
    v_cndmask_b32 v138, 0, v114, s[26:27]
    v_cndmask_b32 v139, 0, v115, s[26:27]
    v_cndmask_b32 v140, 0, v116, s[26:27]
    v_cndmask_b32 v141, 0, v117, s[26:27]
    v_cndmask_b32 v142, 0, v118, s[26:27]
    v_cndmask_b32 v143, 0, v119, s[26:27]
    s_mov_b32 s26, 0xff0000
    s_mov_b32 s27, s26
    v_cndmask_b32 v144, 0, v112, s[26:27]
    v_cndmask_b32 v145, 0, v113, s[26:27]
    s_mov_b32 m0, s29
    s_nop 0
    buffer_load_dwordx4 v2, s[32:35], s28 offen nt lds
    s_add_u32 s28, s28, 65536
    s_add_u32 s29, s29, 1032
    v_cndmask_b32 v146, 0, v114, s[26:27]
    v_cndmask_b32 v147, 0, v115, s[26:27]
    v_cndmask_b32 v148, 0, v116, s[26:27]
    v_cndmask_b32 v149, 0, v117, s[26:27]
    v_cndmask_b32 v150, 0, v118, s[26:27]
    v_cndmask_b32 v151, 0, v119, s[26:27]
    s_mov_b32 s26, 0xff000000
    s_mov_b32 s27, s26
    v_cndmask_b32 v152, 0, v112, s[26:27]
    v_cndmask_b32 v153, 0, v113, s[26:27]
    v_cndmask_b32 v154, 0, v114, s[26:27]
    v_cndmask_b32 v155, 0, v115, s[26:27]
    s_mov_b32 m0, s29
    s_nop 0
    buffer_load_dwordx4 v2, s[32:35], s28 offen nt lds
    s_add_u32 s28, s28, 65536
    s_add_u32 s29, s29, 1032
    v_cndmask_b32 v156, 0, v116, s[26:27]
    v_cndmask_b32 v157, 0, v117, s[26:27]
    v_cndmask_b32 v158, 0, v118, s[26:27]
    v_cndmask_b32 v159, 0, v119, s[26:27]
    v_lshl_add_u32 v9, v6, 8, s21
    v_cvt_f32_u32 v9, v9
    v_mul_f32 v9, 0x3a000000, v9
    v_add_u32 v10, 0, v5
    v_cvt_f32_u32 v10, v10
    v_mul_f32 v11, v10, v9
    s_mov_b32 m0, s29
    s_nop 0
    buffer_load_dwordx4 v2, s[32:35], s28 offen nt lds
    s_add_u32 s28, s28, 65536
    s_add_u32 s29, s29, 1032
    v_mul_f32 v12, 0x3d000000, v10
    v_cos_f32 v104, v12
    v_sin_f32 v105, v12
    v_cos_f32 v96, v11
    v_sin_f32 v97, v11
    s_nop 0
    v_pk_mul_f32 v[98:99], v[96:97], v[104:105] op_sel_hi:[1,0]
    s_mov_b32 m0, s29
    s_nop 0
    buffer_load_dwordx4 v2, s[32:35], s28 offen nt lds
    s_add_u32 s28, s28, 65536
    s_add_u32 s29, s29, 1032
    v_pk_fma_f32 v[98:99], v[96:97], v[104:105], v[98:99] op_sel:[1,1,0] op_sel_hi:[0,1,1] neg_lo:[1,0,0]
    v_pk_mul_f32 v[100:101], v[98:99], v[104:105] op_sel_hi:[1,0]
    v_pk_fma_f32 v[100:101], v[98:99], v[104:105], v[100:101] op_sel:[1,1,0] op_sel_hi:[0,1,1] neg_lo:[1,0,0]
    v_pk_mul_f32 v[102:103], v[100:101], v[104:105] op_sel_hi:[1,0]
    v_pk_fma_f32 v[102:103], v[100:101], v[104:105], v[102:103] op_sel:[1,1,0] op_sel_hi:[0,1,1] neg_lo:[1,0,0]
    v_cvt_pk_bf16_f32 v208, v96, v97
    v_cvt_pk_bf16_f32 v224, -v97, v96
    v_cvt_pk_bf16_f32 v209, v98, v99
    v_cvt_pk_bf16_f32 v225, -v99, v98
    v_cvt_pk_bf16_f32 v210, v100, v101
    v_cvt_pk_bf16_f32 v226, -v101, v100
    v_cvt_pk_bf16_f32 v211, v102, v103
    v_cvt_pk_bf16_f32 v227, -v103, v102
    v_fmamk_f32 v106, v12, 0x41800000, v11
    v_cos_f32 v96, v106
    v_sin_f32 v97, v106
    s_nop 0
    v_pk_mul_f32 v[98:99], v[96:97], v[104:105] op_sel_hi:[1,0]
    v_pk_fma_f32 v[98:99], v[96:97], v[104:105], v[98:99] op_sel:[1,1,0] op_sel_hi:[0,1,1] neg_lo:[1,0,0]
    v_pk_mul_f32 v[100:101], v[98:99], v[104:105] op_sel_hi:[1,0]
    v_pk_fma_f32 v[100:101], v[98:99], v[104:105], v[100:101] op_sel:[1,1,0] op_sel_hi:[0,1,1] neg_lo:[1,0,0]
    v_pk_mul_f32 v[102:103], v[100:101], v[104:105] op_sel_hi:[1,0]
    v_pk_fma_f32 v[102:103], v[100:101], v[104:105], v[102:103] op_sel:[1,1,0] op_sel_hi:[0,1,1] neg_lo:[1,0,0]
    v_cvt_pk_bf16_f32 v212, v96, v97
    v_cvt_pk_bf16_f32 v228, -v97, v96
    v_cvt_pk_bf16_f32 v213, v98, v99
    v_cvt_pk_bf16_f32 v229, -v99, v98
    v_cvt_pk_bf16_f32 v214, v100, v101
    v_cvt_pk_bf16_f32 v230, -v101, v100
    v_cvt_pk_bf16_f32 v215, v102, v103
    v_cvt_pk_bf16_f32 v231, -v103, v102
    v_add_u32 v10, 16, v5
    v_cvt_f32_u32 v10, v10
    v_mul_f32 v11, v10, v9
    v_mul_f32 v12, 0x3d000000, v10
    v_cos_f32 v104, v12
    v_sin_f32 v105, v12
    v_cos_f32 v96, v11
    v_sin_f32 v97, v11
    s_nop 0
    v_pk_mul_f32 v[98:99], v[96:97], v[104:105] op_sel_hi:[1,0]
    v_pk_fma_f32 v[98:99], v[96:97], v[104:105], v[98:99] op_sel:[1,1,0] op_sel_hi:[0,1,1] neg_lo:[1,0,0]
    v_pk_mul_f32 v[100:101], v[98:99], v[104:105] op_sel_hi:[1,0]
    v_pk_fma_f32 v[100:101], v[98:99], v[104:105], v[100:101] op_sel:[1,1,0] op_sel_hi:[0,1,1] neg_lo:[1,0,0]
    v_pk_mul_f32 v[102:103], v[100:101], v[104:105] op_sel_hi:[1,0]
    v_pk_fma_f32 v[102:103], v[100:101], v[104:105], v[102:103] op_sel:[1,1,0] op_sel_hi:[0,1,1] neg_lo:[1,0,0]
    v_cvt_pk_bf16_f32 v216, v96, v97
    v_cvt_pk_bf16_f32 v232, -v97, v96
    v_cvt_pk_bf16_f32 v217, v98, v99
    v_cvt_pk_bf16_f32 v233, -v99, v98
    v_cvt_pk_bf16_f32 v218, v100, v101
    v_cvt_pk_bf16_f32 v234, -v101, v100
    v_cvt_pk_bf16_f32 v219, v102, v103
    v_cvt_pk_bf16_f32 v235, -v103, v102
    v_fmamk_f32 v106, v12, 0x41800000, v11
    v_cos_f32 v96, v106
    v_sin_f32 v97, v106
    s_nop 0
    v_pk_mul_f32 v[98:99], v[96:97], v[104:105] op_sel_hi:[1,0]
    v_pk_fma_f32 v[98:99], v[96:97], v[104:105], v[98:99] op_sel:[1,1,0] op_sel_hi:[0,1,1] neg_lo:[1,0,0]
    v_pk_mul_f32 v[100:101], v[98:99], v[104:105] op_sel_hi:[1,0]
    v_pk_fma_f32 v[100:101], v[98:99], v[104:105], v[100:101] op_sel:[1,1,0] op_sel_hi:[0,1,1] neg_lo:[1,0,0]
    v_pk_mul_f32 v[102:103], v[100:101], v[104:105] op_sel_hi:[1,0]
    v_pk_fma_f32 v[102:103], v[100:101], v[104:105], v[102:103] op_sel:[1,1,0] op_sel_hi:[0,1,1] neg_lo:[1,0,0]
    v_cvt_pk_bf16_f32 v220, v96, v97
    v_cvt_pk_bf16_f32 v236, -v97, v96
    v_cvt_pk_bf16_f32 v221, v98, v99
    v_cvt_pk_bf16_f32 v237, -v99, v98
    v_cvt_pk_bf16_f32 v222, v100, v101
    v_cvt_pk_bf16_f32 v238, -v101, v100
    v_cvt_pk_bf16_f32 v223, v102, v103
    v_cvt_pk_bf16_f32 v239, -v103, v102
    s_waitcnt vmcnt(12)
    v_lshlrev_b32 v108, 16, v108
    s_waitcnt vmcnt(11)
    v_lshlrev_b32 v109, 16, v109
    s_waitcnt vmcnt(10)
    v_lshlrev_b32 v110, 16, v110
    s_waitcnt vmcnt(9)
    v_lshlrev_b32 v111, 16, v111
    v_mul_f32 v96, 0xbfb8aa3b, v108
    v_mul_f32 v97, 0xbfb8aa3b, v109
    v_mul_f32 v98, 0xbfb8aa3b, v110
    v_mul_f32 v99, 0xbfb8aa3b, v111
    v_exp_f32 v96, v96
    v_exp_f32 v97, v97
    v_exp_f32 v98, v98
    v_exp_f32 v99, v99
    v_add_f32 v96, 1.0, v96
    v_add_f32 v97, 1.0, v97
    v_add_f32 v98, 1.0, v98
    v_add_f32 v99, 1.0, v99
    v_rcp_f32 v96, v96
    v_rcp_f32 v97, v97
    v_rcp_f32 v98, v98
    v_rcp_f32 v99, v99
    v_mul_f32 v96, v108, v96
    v_mul_f32 v97, v109, v97
    v_mul_f32 v98, v110, v98
    v_mul_f32 v99, v111, v99
    v_cvt_pk_bf16_f32 v96, v96, v96
    v_cvt_pk_bf16_f32 v97, v97, v97
    v_cvt_pk_bf16_f32 v98, v98, v98
    v_cvt_pk_bf16_f32 v99, v99, v99
    v_lshlrev_b32 v108, 16, v96
    v_lshlrev_b32 v109, 16, v97
    v_lshlrev_b32 v110, 16, v98
    v_lshlrev_b32 v111, 16, v99
    v_accvgpr_write_b32 a236, v108
    v_accvgpr_write_b32 a237, v109
    v_accvgpr_write_b32 a238, v110
    v_accvgpr_write_b32 a239, v111
    s_cmp_lt_u32 s2, 64
    s_cbranch_scc1 L_a2
L_a2_back:
    s_cmp_lt_u32 s2, 64
    s_cbranch_scc1 L_c2
    s_lshl_b32 s24, s95, 9
    s_add_u32 s24, s24, 524288
    s_mov_b32 s22, 0x05040100
    s_mov_b32 s23, 0x07060302
    v_perm_b32 v64, v18, v16, s22
    v_perm_b32 v65, v22, v20, s22
    v_perm_b32 v66, v26, v24, s22
    v_perm_b32 v67, v30, v28, s22
    buffer_store_dwordx4 v[64:67], v56, s[12:15], s24 offen offset:0 sc1
    v_perm_b32 v68, v18, v16, s23
    v_perm_b32 v69, v22, v20, s23
    v_perm_b32 v70, v26, v24, s23
    v_perm_b32 v71, v30, v28, s23
    buffer_store_dwordx4 v[68:71], v56, s[12:15], s24 offen offset:128 sc1
    v_perm_b32 v72, v19, v17, s22
    v_perm_b32 v73, v23, v21, s22
    v_perm_b32 v74, v27, v25, s22
    v_perm_b32 v75, v31, v29, s22
    buffer_store_dwordx4 v[72:75], v56, s[12:15], s24 offen offset:256 sc1
    v_perm_b32 v76, v19, v17, s23
    v_perm_b32 v77, v23, v21, s23
    v_perm_b32 v78, v27, v25, s23
    v_perm_b32 v79, v31, v29, s23
    buffer_store_dwordx4 v[76:79], v56, s[12:15], s24 offen offset:384 sc1
L_c2:
    v_lshrrev_b32 v7, 2, v0
    v_and_b32 v8, 3, v0
    v_mul_u32_u24 v1, 514, v8
    v_add_u32 v1, 60672, v1
    s_waitcnt lgkmcnt(0)
    v_add_u32 v10, s44, v7
    v_sub_u32 v11, 512, v10
    s_sub_u32 s24, s44, 240
    v_mov_b32 v184, s24
    v_add_u32 v9, 128, v184
    v_subrev_u32 v185, 128, v11
    v_cmp_eq_u32 vcc, 0, v7
    s_nop 1
    v_cndmask_b32 v184, v11, v184, vcc
    v_cndmask_b32 v11, v185, v9, vcc
    v_add_u32 v9, 128, v10
    s_cmp_lt_u32 s44, 256
    s_cselect_b64 vcc, -1, 0
    v_cndmask_b32 v184, v184, v10, vcc
    v_cndmask_b32 v11, v11, v9, vcc
    v_lshl_add_u32 v184, v184, 1, v1
    v_lshl_add_u32 v185, v11, 1, v1
    v_mul_u32_u24 v9, 4128, v7
    v_add_u32 v186, v9, v1
    v_lshlrev_b32 v188, 14, v7
    v_lshl_add_u32 v188, v8, 4, v188
    v_add_u32 v187, 4096, v188
    v_mov_b32 v10, 2147483392
    s_cmp_eq_u32 s44, 0
    s_cselect_b32 s24, 4, 0
    v_cmp_gt_u32 vcc, s24, v0
    s_nop 1
    v_cndmask_b32 v188, v188, v10, vcc
    v_lshl_add_u32 v14, v7, 5, v8
    v_add_u32 v14, s42, v14
    v_sub_u32 v14, 2048, v14
    v_and_b32 v14, 2047, v14
    v_mul_u32_u24 v14, 514, v14
    s_cmp_eq_u32 s43, 3
    s_cselect_b32 s24, 16, 0
    v_cmp_gt_u32 vcc, s24, v0
    s_nop 1
    v_cndmask_b32 v14, v10, v14, vcc
    v_bfe_u32 v13, v0, 1, 2
    v_mul_u32_u24 v13, 528, v13
    v_and_b32 v8, 1, v0
    v_lshl_add_u32 v13, v8, 8, v13
    v_lshrrev_b32 v8, 3, v0
    v_lshlrev_b32 v8, 2, v8
    v_add3_u32 v13, v13, v8, s47
    v_lshlrev_b32 v189, 12, v4
    v_lshl_add_u32 v189, v3, 4, v189
    v_lshl_add_u32 v189, s3, 9, v189
    v_lshlrev_b32 v190, 9, v6
    v_lshl_add_u32 v190, v5, 4, v190
    v_lshl_add_u32 v190, s3, 11, v190
    v_lshlrev_b32 v191, 12, v6
    v_lshl_add_u32 v191, v5, 4, v191
    s_cmp_eq_u32 s3, 3
    s_cselect_b32 s22, 0, 2147483392
    s_add_u32 s22, s22, 196608
    v_add_u32 v180, s22, v2
    s_cmp_ge_u32 s3, 2
    s_cselect_b32 s31, 1.0, 0
    s_cmp_eq_u32 s43, 1
    s_cselect_b32 s22, 0, 2048
    v_add_u32 v15, s22, v2
    v_mul_u32_u24 v177, 80, v3
    v_lshl_add_u32 v178, v4, 3, v177
    v_lshl_add_u32 v178, s3, 4, v178
    s_mov_b32 s4, s58
    s_mov_b32 s5, s59
    s_mov_b32 s6, 0x101000
    s_mov_b32 s7, 0x20000
    s_mov_b32 s8, s60
    s_mov_b32 s9, s61
    s_mov_b32 s10, 0x101000
    s_mov_b32 s11, 0x20000
    s_add_u32 s24, s40, 2048
    s_add_u32 s26, s41, 0
    s_mov_b32 m0, s26
    s_nop 0
    buffer_load_dwordx4 v2, s[4:7], s40 offen offset:0 nt lds
    buffer_load_dwordx4 v2, s[4:7], s40 offen offset:1024 nt lds
    s_add_u32 s26, s26, 2048
    s_mov_b32 m0, s26
    s_mov_b64 exec, 1
    buffer_load_dwordx4 v2, s[4:7], s24 offen nt lds
    s_mov_b64 exec, -1
    s_add_u32 s26, s41, 2064
    s_mov_b32 m0, s26
    s_nop 0
    buffer_load_dwordx4 v2, s[8:11], s40 offen offset:0 nt lds
    buffer_load_dwordx4 v2, s[8:11], s40 offen offset:1024 nt lds
    s_add_u32 s26, s26, 2048
    s_mov_b32 m0, s26
    s_mov_b64 exec, 1
    buffer_load_dwordx4 v2, s[8:11], s24 offen nt lds
    s_mov_b64 exec, -1
    buffer_load_ushort v196, v14, s[4:7], 0 offen offset:0 nt
    buffer_load_ushort v197, v14, s[4:7], 0 offen offset:512 nt
    buffer_load_ushort v198, v14, s[8:11], 0 offen offset:0 nt
    buffer_load_ushort v199, v14, s[8:11], 0 offen offset:512 nt
    s_mov_b32 s29, s51
    s_mov_b32 s8, s72
    s_mov_b32 s9, s73
    s_mov_b32 s10, 0x300000
    s_mov_b32 s11, 0x20000
    v_lshl_add_u32 v7, s3, 6, v0
    v_lshrrev_b32 v8, 3, v7
    v_and_b32 v9, 7, v0
    v_mul_u32_u24 v11, 6144, v8
    v_lshl_add_u32 v11, v9, 4, v11
    v_lshrrev_b32 v182, 4, v7
    v_lshlrev_b32 v182, 8, v182
    v_lshl_add_u32 v182, v9, 5, v182
    v_lshlrev_b32 v183, 2, v0
    s_load_dwordx16 s[56:71], s[18:19], 64
    s_load_dwordx8 s[72:79], s[18:19], 128
    global_load_dwordx4 v[200:203], v15, s[16:17] offset:0
    global_load_dwordx4 v[204:207], v15, s[16:17] offset:1024
    v_mov_b32 v176, v11
    v_mul_u32_u24 v9, 1032, v3
    v_lshl_add_u32 v9, v4, 7, v9
    v_lshl_add_u32 v9, s3, 3, v9
    s_waitcnt vmcnt(12)
L_xw2:
    s_barrier
    ds_read_b64 v[80:81], v9 offset:0
    ds_read_b64 v[82:83], v9 offset:32
    ds_read_b64 v[84:85], v9 offset:64
    ds_read_b64 v[86:87], v9 offset:96
    ds_read_b64 v[88:89], v9 offset:256
    ds_read_b64 v[90:91], v9 offset:288
    ds_read_b64 v[92:93], v9 offset:320
    ds_read_b64 v[94:95], v9 offset:352
    ds_read_b64 v[96:97], v9 offset:512
    ds_read_b64 v[98:99], v9 offset:544
    ds_read_b64 v[100:101], v9 offset:576
    ds_read_b64 v[102:103], v9 offset:608
    ds_read_b64 v[104:105], v9 offset:768
    ds_read_b64 v[106:107], v9 offset:800
    ds_read_b64 v[108:109], v9 offset:832
    ds_read_b64 v[110:111], v9 offset:864
    v_cmp_eq_u32 vcc, 0, v181
    s_nop 1
    s_cbranch_vccnz L_ncw
L_ncw_back:
    v_mov_b32 v8, 0
    v_readfirstlane_b32 s94, v181
    s_mov_b64 exec, 1
    buffer_store_dword v181, v8, s[12:15], s49 offen sc1
    s_mov_b64 exec, -1
    s_add_u32 s32, s12, 0x80000
    s_addc_u32 s33, s13, 0
    s_mov_b32 s34, 0x158000
    s_mov_b32 s35, 0x20000
    s_add_u32 s36, s12, 0x800000
    s_addc_u32 s37, s13, 0
    s_mov_b32 s38, 0x160000
    s_mov_b32 s39, 0x20000
    s_waitcnt lgkmcnt(0)
    v_lshlrev_b32 v16, 16, v80
    v_and_b32 v32, 0xffff0000, v80
    v_lshlrev_b32 v48, 16, v81
    v_and_b32 v64, 0xffff0000, v81
    v_lshlrev_b32 v17, 16, v82
    v_and_b32 v33, 0xffff0000, v82
    v_lshlrev_b32 v49, 16, v83
    v_and_b32 v65, 0xffff0000, v83
    v_lshlrev_b32 v18, 16, v84
    v_and_b32 v34, 0xffff0000, v84
    v_lshlrev_b32 v50, 16, v85
    v_and_b32 v66, 0xffff0000, v85
    v_lshlrev_b32 v19, 16, v86
    v_and_b32 v35, 0xffff0000, v86
    s_add_u32 s24, s46, 0
    buffer_load_dwordx4 v[160:163], v2, s[12:15], s24 offen offset:0 sc1
    v_lshlrev_b32 v51, 16, v87
    v_and_b32 v67, 0xffff0000, v87
    v_lshlrev_b32 v20, 16, v88
    v_and_b32 v36, 0xffff0000, v88
    v_lshlrev_b32 v52, 16, v89
    v_and_b32 v68, 0xffff0000, v89
    v_lshlrev_b32 v21, 16, v90
    v_and_b32 v37, 0xffff0000, v90
    v_lshlrev_b32 v53, 16, v91
    v_and_b32 v69, 0xffff0000, v91
    v_lshlrev_b32 v22, 16, v92
    v_and_b32 v38, 0xffff0000, v92
    v_lshlrev_b32 v54, 16, v93
    v_and_b32 v70, 0xffff0000, v93
    buffer_load_dwordx4 v[240:243], v2, s[12:15], s24 offen offset:1024 sc1
    v_lshlrev_b32 v23, 16, v94
    v_and_b32 v39, 0xffff0000, v94
    v_lshlrev_b32 v55, 16, v95
    v_and_b32 v71, 0xffff0000, v95
    v_lshlrev_b32 v24, 16, v96
    v_and_b32 v40, 0xffff0000, v96
    v_lshlrev_b32 v56, 16, v97
    v_and_b32 v72, 0xffff0000, v97
    v_lshlrev_b32 v25, 16, v98
    v_and_b32 v41, 0xffff0000, v98
    v_lshlrev_b32 v57, 16, v99
    v_and_b32 v73, 0xffff0000, v99
    v_lshlrev_b32 v26, 16, v100
    v_and_b32 v42, 0xffff0000, v100
    s_add_u32 s24, s46, 8192
    buffer_load_dwordx4 v[164:167], v2, s[12:15], s24 offen offset:0 sc1
    v_lshlrev_b32 v58, 16, v101
    v_and_b32 v74, 0xffff0000, v101
    v_lshlrev_b32 v27, 16, v102
    v_and_b32 v43, 0xffff0000, v102
    v_lshlrev_b32 v59, 16, v103
    v_and_b32 v75, 0xffff0000, v103
    v_lshlrev_b32 v28, 16, v104
    v_and_b32 v44, 0xffff0000, v104
    v_lshlrev_b32 v60, 16, v105
    v_and_b32 v76, 0xffff0000, v105
    v_lshlrev_b32 v29, 16, v106
    v_and_b32 v45, 0xffff0000, v106
    v_lshlrev_b32 v61, 16, v107
    v_and_b32 v77, 0xffff0000, v107
    buffer_load_dwordx4 v[244:247], v2, s[12:15], s24 offen offset:1024 sc1
    v_lshlrev_b32 v30, 16, v108
    v_and_b32 v46, 0xffff0000, v108
    v_lshlrev_b32 v62, 16, v109
    v_and_b32 v78, 0xffff0000, v109
    v_lshlrev_b32 v31, 16, v110
    v_and_b32 v47, 0xffff0000, v110
    v_lshlrev_b32 v63, 16, v111
    v_and_b32 v79, 0xffff0000, v111
    v_pk_add_f32 v[112:113], v[16:17], v[18:19]
    v_pk_mul_f32 v[114:115], v[16:17], v[16:17]
    v_pk_add_f32 v[116:117], v[20:21], v[22:23]
    v_pk_mul_f32 v[118:119], v[18:19], v[18:19]
    v_pk_fma_f32 v[114:115], v[20:21], v[20:21], v[114:115]
    v_pk_fma_f32 v[118:119], v[22:23], v[22:23], v[118:119]
    s_add_u32 s24, s46, 16384
    buffer_load_dwordx4 v[168:171], v2, s[12:15], s24 offen offset:0 sc1
    v_pk_add_f32 v[112:113], v[112:113], v[24:25]
    v_pk_fma_f32 v[114:115], v[24:25], v[24:25], v[114:115]
    v_pk_add_f32 v[116:117], v[116:117], v[26:27]
    v_pk_fma_f32 v[118:119], v[26:27], v[26:27], v[118:119]
    v_pk_add_f32 v[112:113], v[112:113], v[28:29]
    v_pk_fma_f32 v[114:115], v[28:29], v[28:29], v[114:115]
    v_pk_add_f32 v[116:117], v[116:117], v[30:31]
    v_pk_fma_f32 v[118:119], v[30:31], v[30:31], v[118:119]
    v_pk_add_f32 v[112:113], v[112:113], v[32:33]
    v_pk_fma_f32 v[114:115], v[32:33], v[32:33], v[114:115]
    v_pk_add_f32 v[116:117], v[116:117], v[34:35]
    v_pk_fma_f32 v[118:119], v[34:35], v[34:35], v[118:119]
    v_pk_add_f32 v[112:113], v[112:113], v[36:37]
    v_pk_fma_f32 v[114:115], v[36:37], v[36:37], v[114:115]
    buffer_load_dwordx4 v[248:251], v2, s[12:15], s24 offen offset:1024 sc1
    v_pk_add_f32 v[116:117], v[116:117], v[38:39]
    v_pk_fma_f32 v[118:119], v[38:39], v[38:39], v[118:119]
    v_pk_add_f32 v[112:113], v[112:113], v[40:41]
    v_pk_fma_f32 v[114:115], v[40:41], v[40:41], v[114:115]
    v_pk_add_f32 v[116:117], v[116:117], v[42:43]
    v_pk_fma_f32 v[118:119], v[42:43], v[42:43], v[118:119]
    v_pk_add_f32 v[112:113], v[112:113], v[44:45]
    v_pk_fma_f32 v[114:115], v[44:45], v[44:45], v[114:115]
    v_pk_add_f32 v[116:117], v[116:117], v[46:47]
    v_pk_fma_f32 v[118:119], v[46:47], v[46:47], v[118:119]
    v_pk_add_f32 v[112:113], v[112:113], v[48:49]
    v_pk_fma_f32 v[114:115], v[48:49], v[48:49], v[114:115]
    v_pk_add_f32 v[116:117], v[116:117], v[50:51]
    v_pk_fma_f32 v[118:119], v[50:51], v[50:51], v[118:119]
    s_add_u32 s24, s46, 24576
    buffer_load_dwordx4 v[172:175], v2, s[12:15], s24 offen offset:0 sc1
    v_pk_add_f32 v[112:113], v[112:113], v[52:53]
    v_pk_fma_f32 v[114:115], v[52:53], v[52:53], v[114:115]
    v_pk_add_f32 v[116:117], v[116:117], v[54:55]
    v_pk_fma_f32 v[118:119], v[54:55], v[54:55], v[118:119]
    v_pk_add_f32 v[112:113], v[112:113], v[56:57]
    v_pk_fma_f32 v[114:115], v[56:57], v[56:57], v[114:115]
    v_pk_add_f32 v[116:117], v[116:117], v[58:59]
    v_pk_fma_f32 v[118:119], v[58:59], v[58:59], v[118:119]
    v_pk_add_f32 v[112:113], v[112:113], v[60:61]
    v_pk_fma_f32 v[114:115], v[60:61], v[60:61], v[114:115]
    v_pk_add_f32 v[116:117], v[116:117], v[62:63]
    v_pk_fma_f32 v[118:119], v[62:63], v[62:63], v[118:119]
    v_pk_add_f32 v[112:113], v[112:113], v[64:65]
    v_pk_fma_f32 v[114:115], v[64:65], v[64:65], v[114:115]
    buffer_load_dwordx4 v[252:255], v2, s[12:15], s24 offen offset:1024 sc1
    v_pk_add_f32 v[116:117], v[116:117], v[66:67]
    v_pk_fma_f32 v[118:119], v[66:67], v[66:67], v[118:119]
    v_pk_add_f32 v[112:113], v[112:113], v[68:69]
    v_pk_fma_f32 v[114:115], v[68:69], v[68:69], v[114:115]
    v_pk_add_f32 v[116:117], v[116:117], v[70:71]
    v_pk_fma_f32 v[118:119], v[70:71], v[70:71], v[118:119]
    v_pk_add_f32 v[112:113], v[112:113], v[72:73]
    v_pk_fma_f32 v[114:115], v[72:73], v[72:73], v[114:115]
    v_pk_add_f32 v[116:117], v[116:117], v[74:75]
    v_pk_fma_f32 v[118:119], v[74:75], v[74:75], v[118:119]
    v_pk_add_f32 v[112:113], v[112:113], v[76:77]
    v_pk_fma_f32 v[114:115], v[76:77], v[76:77], v[114:115]
    v_pk_add_f32 v[116:117], v[116:117], v[78:79]
    v_pk_fma_f32 v[118:119], v[78:79], v[78:79], v[118:119]
    buffer_load_dwordx4 a[240:243], v176, s[8:11], s50 offen nt
    s_add_u32 s50, s50, 196608
    v_pk_add_f32 v[112:113], v[112:113], v[116:117]
    v_pk_add_f32 v[114:115], v[114:115], v[118:119]
    v_add_f32 v112, v112, v113
    v_add_f32 v113, v114, v115
    ds_write_b64 v178, v[112:113] offset:33280
    v_lshl_add_u32 v12, v4, 4, s79
    s_waitcnt lgkmcnt(0)
    s_barrier
    ds_read_b128 v[112:115], v177 offset:33280
    ds_read_b128 v[116:119], v177 offset:33296
    ds_read_b128 v[120:123], v177 offset:33312
    ds_read_b128 v[124:127], v177 offset:33328
    s_waitcnt lgkmcnt(3)
    v_pk_add_f32 v[112:113], v[112:113], v[114:115]
    s_waitcnt lgkmcnt(2)
    v_pk_add_f32 v[116:117], v[116:117], v[118:119]
    s_waitcnt lgkmcnt(1)
    v_pk_add_f32 v[120:121], v[120:121], v[122:123]
    s_waitcnt lgkmcnt(0)
    v_pk_add_f32 v[124:125], v[124:125], v[126:127]
    buffer_load_dwordx4 a[244:247], v176, s[8:11], s50 offen nt
    s_add_u32 s50, s50, 196608
    v_pk_add_f32 v[112:113], v[112:113], v[116:117]
    v_pk_add_f32 v[120:121], v[120:121], v[124:125]
    v_pk_add_f32 v[112:113], v[112:113], v[120:121]
    v_mul_f32 v112, 0x3b000000, v112
    v_mul_f32 v113, 0x3b000000, v113
    v_fma_f32 v113, -v112, v112, v113
    v_max_f32 v113, 0, v113
    v_add_f32 v113, 0x3727c5ac, v113
    v_rsq_f32 v14, v113
    s_nop 0
    v_mul_f32 v15, -v112, v14
    v_pk_fma_f32 v[16:17], v[16:17], v[14:15], v[14:15] op_sel:[0,0,1] op_sel_hi:[1,0,1]
    v_pk_fma_f32 v[18:19], v[18:19], v[14:15], v[14:15] op_sel:[0,0,1] op_sel_hi:[1,0,1]
    v_pk_fma_f32 v[20:21], v[20:21], v[14:15], v[14:15] op_sel:[0,0,1] op_sel_hi:[1,0,1]
    buffer_load_dwordx4 a[248:251], v176, s[8:11], s50 offen nt
    s_add_u32 s50, s50, 196608
    v_pk_fma_f32 v[22:23], v[22:23], v[14:15], v[14:15] op_sel:[0,0,1] op_sel_hi:[1,0,1]
    v_pk_fma_f32 v[24:25], v[24:25], v[14:15], v[14:15] op_sel:[0,0,1] op_sel_hi:[1,0,1]
    v_pk_fma_f32 v[26:27], v[26:27], v[14:15], v[14:15] op_sel:[0,0,1] op_sel_hi:[1,0,1]
    v_pk_fma_f32 v[28:29], v[28:29], v[14:15], v[14:15] op_sel:[0,0,1] op_sel_hi:[1,0,1]
    v_pk_fma_f32 v[30:31], v[30:31], v[14:15], v[14:15] op_sel:[0,0,1] op_sel_hi:[1,0,1]
    v_pk_fma_f32 v[32:33], v[32:33], v[14:15], v[14:15] op_sel:[0,0,1] op_sel_hi:[1,0,1]
    v_pk_fma_f32 v[34:35], v[34:35], v[14:15], v[14:15] op_sel:[0,0,1] op_sel_hi:[1,0,1]
    v_pk_fma_f32 v[36:37], v[36:37], v[14:15], v[14:15] op_sel:[0,0,1] op_sel_hi:[1,0,1]
    v_pk_fma_f32 v[38:39], v[38:39], v[14:15], v[14:15] op_sel:[0,0,1] op_sel_hi:[1,0,1]
    v_pk_fma_f32 v[40:41], v[40:41], v[14:15], v[14:15] op_sel:[0,0,1] op_sel_hi:[1,0,1]
    v_pk_fma_f32 v[42:43], v[42:43], v[14:15], v[14:15] op_sel:[0,0,1] op_sel_hi:[1,0,1]
    v_pk_fma_f32 v[44:45], v[44:45], v[14:15], v[14:15] op_sel:[0,0,1] op_sel_hi:[1,0,1]
    v_pk_fma_f32 v[46:47], v[46:47], v[14:15], v[14:15] op_sel:[0,0,1] op_sel_hi:[1,0,1]
    v_pk_fma_f32 v[48:49], v[48:49], v[14:15], v[14:15] op_sel:[0,0,1] op_sel_hi:[1,0,1]
    buffer_load_dwordx4 a[252:255], v176, s[8:11], s50 offen nt
    v_pk_fma_f32 v[50:51], v[50:51], v[14:15], v[14:15] op_sel:[0,0,1] op_sel_hi:[1,0,1]
    v_pk_fma_f32 v[52:53], v[52:53], v[14:15], v[14:15] op_sel:[0,0,1] op_sel_hi:[1,0,1]
    v_pk_fma_f32 v[54:55], v[54:55], v[14:15], v[14:15] op_sel:[0,0,1] op_sel_hi:[1,0,1]
    v_pk_fma_f32 v[56:57], v[56:57], v[14:15], v[14:15] op_sel:[0,0,1] op_sel_hi:[1,0,1]
    v_pk_fma_f32 v[58:59], v[58:59], v[14:15], v[14:15] op_sel:[0,0,1] op_sel_hi:[1,0,1]
    v_pk_fma_f32 v[60:61], v[60:61], v[14:15], v[14:15] op_sel:[0,0,1] op_sel_hi:[1,0,1]
    v_pk_fma_f32 v[62:63], v[62:63], v[14:15], v[14:15] op_sel:[0,0,1] op_sel_hi:[1,0,1]
    v_pk_fma_f32 v[64:65], v[64:65], v[14:15], v[14:15] op_sel:[0,0,1] op_sel_hi:[1,0,1]
    v_pk_fma_f32 v[66:67], v[66:67], v[14:15], v[14:15] op_sel:[0,0,1] op_sel_hi:[1,0,1]
    v_pk_fma_f32 v[68:69], v[68:69], v[14:15], v[14:15] op_sel:[0,0,1] op_sel_hi:[1,0,1]
    v_pk_fma_f32 v[70:71], v[70:71], v[14:15], v[14:15] op_sel:[0,0,1] op_sel_hi:[1,0,1]
    v_pk_fma_f32 v[72:73], v[72:73], v[14:15], v[14:15] op_sel:[0,0,1] op_sel_hi:[1,0,1]
    v_pk_fma_f32 v[74:75], v[74:75], v[14:15], v[14:15] op_sel:[0,0,1] op_sel_hi:[1,0,1]
    v_pk_fma_f32 v[76:77], v[76:77], v[14:15], v[14:15] op_sel:[0,0,1] op_sel_hi:[1,0,1]
    v_pk_fma_f32 v[78:79], v[78:79], v[14:15], v[14:15] op_sel:[0,0,1] op_sel_hi:[1,0,1]
    s_waitcnt vmcnt(11)
    v_xor_b32 v8, v161, v181
    s_waitcnt vmcnt(10)
    v_bitop3_b32 v8, v241, v181, v8 bitop3:0xbe
    v_bitop3_b32 v8, v163, v181, v8 bitop3:0xbe
    v_bitop3_b32 v8, v243, v181, v8 bitop3:0xbe
    s_waitcnt vmcnt(9)
    v_bitop3_b32 v8, v165, v181, v8 bitop3:0xbe
    s_waitcnt vmcnt(8)
    v_bitop3_b32 v8, v245, v181, v8 bitop3:0xbe
    v_bitop3_b32 v8, v167, v181, v8 bitop3:0xbe
    v_bitop3_b32 v8, v247, v181, v8 bitop3:0xbe
    s_waitcnt vmcnt(7)
    v_bitop3_b32 v8, v169, v181, v8 bitop3:0xbe
    s_waitcnt vmcnt(6)
    v_bitop3_b32 v8, v249, v181, v8 bitop3:0xbe
    v_bitop3_b32 v8, v171, v181, v8 bitop3:0xbe
    v_bitop3_b32 v8, v251, v181, v8 bitop3:0xbe
    s_waitcnt vmcnt(5)
    v_bitop3_b32 v8, v173, v181, v8 bitop3:0xbe
    s_waitcnt vmcnt(4)
    v_bitop3_b32 v8, v253, v181, v8 bitop3:0xbe
    v_bitop3_b32 v8, v175, v181, v8 bitop3:0xbe
    v_bitop3_b32 v8, v255, v181, v8 bitop3:0xbe
    v_cmp_ne_u32 vcc, 0, v8
    s_nop 1
    s_cbranch_vccnz L_mp
L_mp_back:
    v_add_f32 v164, v160, v164
    v_add_f32 v168, v168, v172
    v_add_f32 v166, v162, v166
    v_add_f32 v170, v170, v174
    v_add_f32 v244, v240, v244
    v_add_f32 v248, v248, v252
    v_add_f32 v246, v242, v246
    v_add_f32 v250, v250, v254
    v_add_f32 v160, v164, v168
    v_add_f32 v161, v166, v170
    v_add_f32 v162, v244, v248
    v_add_f32 v163, v246, v250
    v_cvt_pk_bf16_f32 v164, v160, v161
    v_cvt_pk_bf16_f32 v165, v162, v163
    v_lshlrev_b32 v160, 16, v164
    v_and_b32 v161, 0xffff0000, v164
    v_lshlrev_b32 v162, 16, v165
    v_and_b32 v163, 0xffff0000, v165
    v_add_f32 v160, s31, v160
    v_add_f32 v161, s31, v161
    v_add_f32 v162, s31, v162
    v_add_f32 v163, s31, v163
    v_cvt_pk_bf16_f32 v164, v160, v161
    v_cvt_pk_bf16_f32 v165, v162, v163
    v_lshlrev_b32 v160, 16, v164
    v_and_b32 v161, 0xffff0000, v164
    v_lshlrev_b32 v162, 16, v165
    v_and_b32 v163, 0xffff0000, v165
    ds_write_b32 v13, v160 offset:0
    ds_write_b32 v13, v161 offset:128
    ds_write_b32 v13, v162 offset:32
    ds_write_b32 v13, v163 offset:160
    s_waitcnt lgkmcnt(0)
    s_barrier
    ds_read_b128 v[112:115], v12 offset:0
    ds_read_b128 v[116:119], v12 offset:2112
    ds_read_b128 v[120:123], v12 offset:32
    ds_read_b128 v[124:127], v12 offset:2144
    ds_read_b128 v[240:243], v12 offset:64
    ds_read_b128 v[244:247], v12 offset:2176
    buffer_load_dword v192, v180, s[12:15], 0 offen offset:0 sc1
    buffer_load_dword v193, v180, s[12:15], 0 offen offset:1024 sc1
    buffer_load_dword v194, v180, s[12:15], 0 offen offset:2048 sc1
    ds_read_b128 v[248:251], v12 offset:96
    ds_read_b128 v[252:255], v12 offset:2208
    s_waitcnt lgkmcnt(6)
    v_pk_fma_f32 v[16:17], v[16:17], v[116:117], v[112:113]
    v_pk_fma_f32 v[18:19], v[18:19], v[118:119], v[114:115]
    v_cvt_pk_bf16_f32 v80, v16, v17
    v_cvt_pk_bf16_f32 v81, v18, v19
    ds_read_b128 v[112:115], v12 offset:128
    ds_read_b128 v[116:119], v12 offset:2240
    s_waitcnt lgkmcnt(6)
    v_pk_fma_f32 v[20:21], v[20:21], v[124:125], v[120:121]
    v_pk_fma_f32 v[22:23], v[22:23], v[126:127], v[122:123]
    v_cvt_pk_bf16_f32 v82, v20, v21
    v_cvt_pk_bf16_f32 v83, v22, v23
    ds_read_b128 v[120:123], v12 offset:160
    ds_read_b128 v[124:127], v12 offset:2272
    s_waitcnt lgkmcnt(6)
    v_pk_fma_f32 v[24:25], v[24:25], v[244:245], v[240:241]
    v_pk_fma_f32 v[26:27], v[26:27], v[246:247], v[242:243]
    v_cvt_pk_bf16_f32 v84, v24, v25
    v_cvt_pk_bf16_f32 v85, v26, v27
    v_mfma_f32_32x32x16_bf16 v[160:175], v[128:131], v[80:83], 0
    ds_read_b128 v[240:243], v12 offset:192
    ds_read_b128 v[244:247], v12 offset:2304
    s_waitcnt lgkmcnt(6)
    v_fmac_f32 v248, v28, v252
    v_fmac_f32 v249, v29, v253
    v_fmac_f32 v250, v30, v254
    v_fmac_f32 v251, v31, v255
    v_cvt_pk_bf16_f32 v86, v248, v249
    v_cvt_pk_bf16_f32 v87, v250, v251
    ds_read_b128 v[248:251], v12 offset:224
    ds_read_b128 v[252:255], v12 offset:2336
    s_waitcnt lgkmcnt(6)
    v_pk_fma_f32 v[32:33], v[32:33], v[116:117], v[112:113]
    v_pk_fma_f32 v[34:35], v[34:35], v[118:119], v[114:115]
    v_cvt_pk_bf16_f32 v88, v32, v33
    v_cvt_pk_bf16_f32 v89, v34, v35
    v_mfma_f32_32x32x16_bf16 v[160:175], v[132:135], v[84:87], v[160:175]
    ds_read_b128 v[112:115], v12 offset:256
    ds_read_b128 v[116:119], v12 offset:2368
    s_waitcnt lgkmcnt(6)
    v_fmac_f32 v120, v36, v124
    v_fmac_f32 v121, v37, v125
    v_fmac_f32 v122, v38, v126
    v_fmac_f32 v123, v39, v127
    v_cvt_pk_bf16_f32 v90, v120, v121
    v_cvt_pk_bf16_f32 v91, v122, v123
    ds_read_b128 v[120:123], v12 offset:288
    ds_read_b128 v[124:127], v12 offset:2400
    s_waitcnt lgkmcnt(6)
    v_pk_fma_f32 v[40:41], v[40:41], v[244:245], v[240:241]
    v_pk_fma_f32 v[42:43], v[42:43], v[246:247], v[242:243]
    v_cvt_pk_bf16_f32 v92, v40, v41
    v_cvt_pk_bf16_f32 v93, v42, v43
    v_mfma_f32_32x32x16_bf16 v[160:175], v[136:139], v[88:91], v[160:175]
    ds_read_b128 v[240:243], v12 offset:320
    ds_read_b128 v[244:247], v12 offset:2432
    s_waitcnt lgkmcnt(6)
    v_fmac_f32 v248, v44, v252
    v_fmac_f32 v249, v45, v253
    v_fmac_f32 v250, v46, v254
    v_fmac_f32 v251, v47, v255
    v_cvt_pk_bf16_f32 v94, v248, v249
    v_cvt_pk_bf16_f32 v95, v250, v251
    ds_read_b128 v[248:251], v12 offset:352
    ds_read_b128 v[252:255], v12 offset:2464
    s_waitcnt lgkmcnt(6)
    v_pk_fma_f32 v[48:49], v[48:49], v[116:117], v[112:113]
    v_pk_fma_f32 v[50:51], v[50:51], v[118:119], v[114:115]
    v_cvt_pk_bf16_f32 v96, v48, v49
    v_cvt_pk_bf16_f32 v97, v50, v51
    v_mfma_f32_32x32x16_bf16 v[160:175], v[140:143], v[92:95], v[160:175]
    ds_read_b128 v[112:115], v12 offset:384
    ds_read_b128 v[116:119], v12 offset:2496
    s_waitcnt lgkmcnt(6)
    v_fmac_f32 v120, v52, v124
    v_fmac_f32 v121, v53, v125
    v_fmac_f32 v122, v54, v126
    v_fmac_f32 v123, v55, v127
    v_cvt_pk_bf16_f32 v98, v120, v121
    v_cvt_pk_bf16_f32 v99, v122, v123
    ds_read_b128 v[120:123], v12 offset:416
    ds_read_b128 v[124:127], v12 offset:2528
    s_waitcnt lgkmcnt(6)
    v_pk_fma_f32 v[56:57], v[56:57], v[244:245], v[240:241]
    v_pk_fma_f32 v[58:59], v[58:59], v[246:247], v[242:243]
    v_cvt_pk_bf16_f32 v100, v56, v57
    v_cvt_pk_bf16_f32 v101, v58, v59
    v_mfma_f32_32x32x16_bf16 v[160:175], v[144:147], v[96:99], v[160:175]
    ds_read_b128 v[240:243], v12 offset:448
    ds_read_b128 v[244:247], v12 offset:2560
    s_waitcnt lgkmcnt(6)
    v_fmac_f32 v248, v60, v252
    v_fmac_f32 v249, v61, v253
    v_fmac_f32 v250, v62, v254
    v_fmac_f32 v251, v63, v255
    v_cvt_pk_bf16_f32 v102, v248, v249
    v_cvt_pk_bf16_f32 v103, v250, v251
    ds_read_b128 v[248:251], v12 offset:480
    ds_read_b128 v[252:255], v12 offset:2592
    s_waitcnt lgkmcnt(6)
    v_pk_fma_f32 v[64:65], v[64:65], v[116:117], v[112:113]
    v_pk_fma_f32 v[66:67], v[66:67], v[118:119], v[114:115]
    v_cvt_pk_bf16_f32 v104, v64, v65
    v_cvt_pk_bf16_f32 v105, v66, v67
    v_mfma_f32_32x32x16_bf16 v[160:175], v[148:151], v[100:103], v[160:175]
    s_waitcnt lgkmcnt(4)
    v_fmac_f32 v120, v68, v124
    v_fmac_f32 v121, v69, v125
    v_fmac_f32 v122, v70, v126
    v_fmac_f32 v123, v71, v127
    v_cvt_pk_bf16_f32 v106, v120, v121
    v_cvt_pk_bf16_f32 v107, v122, v123
    s_waitcnt lgkmcnt(2)
    v_pk_fma_f32 v[72:73], v[72:73], v[244:245], v[240:241]
    v_pk_fma_f32 v[74:75], v[74:75], v[246:247], v[242:243]
    v_cvt_pk_bf16_f32 v108, v72, v73
    v_cvt_pk_bf16_f32 v109, v74, v75
    v_mfma_f32_32x32x16_bf16 v[160:175], v[152:155], v[104:107], v[160:175]
    s_waitcnt lgkmcnt(0)
    v_fmac_f32 v248, v76, v252
    v_fmac_f32 v249, v77, v253
    v_fmac_f32 v250, v78, v254
    v_fmac_f32 v251, v79, v255
    v_cvt_pk_bf16_f32 v110, v248, v249
    v_cvt_pk_bf16_f32 v111, v250, v251
    s_nop 1
    v_mfma_f32_32x32x16_bf16 v[160:175], v[156:159], v[108:111], v[160:175]
    s_nop 11
    v_cvt_pk_bf16_f32 v16, v160, v161
    v_cvt_pk_bf16_f32 v17, v164, v165
    v_cvt_pk_bf16_f32 v18, v168, v169
    v_cvt_pk_bf16_f32 v19, v172, v173
    ds_write_b128 v189, v[16:19] offset:35840
    v_cvt_pk_bf16_f32 v20, v162, v163
    v_cvt_pk_bf16_f32 v21, v166, v167
    v_cvt_pk_bf16_f32 v22, v170, v171
    v_cvt_pk_bf16_f32 v23, v174, v175
    ds_write_b128 v189, v[20:23] offset:37888
    s_cmp_ge_u32 s29, 2147483392
    s_cbranch_scc1 L_b2_done
    v_accvgpr_read_b32 v128, a236
    v_accvgpr_read_b32 v129, a237
    v_accvgpr_read_b32 v130, a238
    v_accvgpr_read_b32 v131, a239
    s_waitcnt vmcnt(6)
    v_accvgpr_read_b32 v132, a240
    v_accvgpr_read_b32 v133, a241
    v_accvgpr_read_b32 v134, a242
    v_accvgpr_read_b32 v135, a243
    s_waitcnt vmcnt(5)
    v_accvgpr_read_b32 v136, a244
    v_accvgpr_read_b32 v137, a245
    v_accvgpr_read_b32 v138, a246
    v_accvgpr_read_b32 v139, a247
    s_waitcnt vmcnt(4)
    v_accvgpr_read_b32 v140, a248
    v_accvgpr_read_b32 v141, a249
    v_accvgpr_read_b32 v142, a250
    v_accvgpr_read_b32 v143, a251
    s_waitcnt vmcnt(3)
    v_accvgpr_read_b32 v144, a252
    v_accvgpr_read_b32 v145, a253
    v_accvgpr_read_b32 v146, a254
    v_accvgpr_read_b32 v147, a255
    v_lshlrev_b32 v120, 16, v132
    v_and_b32 v121, 0xffff0000, v132
    v_lshlrev_b32 v122, 16, v133
    v_and_b32 v123, 0xffff0000, v133
    v_lshlrev_b32 v124, 16, v134
    v_and_b32 v125, 0xffff0000, v134
    v_lshlrev_b32 v126, 16, v135
    v_and_b32 v127, 0xffff0000, v135
    v_pk_mul_f32 v[112:113], v[120:121], v[128:129] op_sel:[0,0] op_sel_hi:[1,0]
    v_pk_mul_f32 v[114:115], v[122:123], v[128:129] op_sel:[0,0] op_sel_hi:[1,0]
    v_pk_mul_f32 v[116:117], v[124:125], v[128:129] op_sel:[0,0] op_sel_hi:[1,0]
    v_pk_mul_f32 v[118:119], v[126:127], v[128:129] op_sel:[0,0] op_sel_hi:[1,0]
    v_lshlrev_b32 v120, 16, v136
    v_and_b32 v121, 0xffff0000, v136
    v_lshlrev_b32 v122, 16, v137
    v_and_b32 v123, 0xffff0000, v137
    v_lshlrev_b32 v124, 16, v138
    v_and_b32 v125, 0xffff0000, v138
    v_lshlrev_b32 v126, 16, v139
    v_and_b32 v127, 0xffff0000, v139
    v_pk_fma_f32 v[112:113], v[120:121], v[128:129], v[112:113] op_sel:[0,1,0] op_sel_hi:[1,1,1]
    v_pk_fma_f32 v[114:115], v[122:123], v[128:129], v[114:115] op_sel:[0,1,0] op_sel_hi:[1,1,1]
    v_pk_fma_f32 v[116:117], v[124:125], v[128:129], v[116:117] op_sel:[0,1,0] op_sel_hi:[1,1,1]
    v_pk_fma_f32 v[118:119], v[126:127], v[128:129], v[118:119] op_sel:[0,1,0] op_sel_hi:[1,1,1]
    v_lshlrev_b32 v120, 16, v140
    v_and_b32 v121, 0xffff0000, v140
    v_lshlrev_b32 v122, 16, v141
    v_and_b32 v123, 0xffff0000, v141
    v_lshlrev_b32 v124, 16, v142
    v_and_b32 v125, 0xffff0000, v142
    v_lshlrev_b32 v126, 16, v143
    v_and_b32 v127, 0xffff0000, v143
    v_pk_fma_f32 v[112:113], v[120:121], v[130:131], v[112:113] op_sel:[0,0,0] op_sel_hi:[1,0,1]
    v_pk_fma_f32 v[114:115], v[122:123], v[130:131], v[114:115] op_sel:[0,0,0] op_sel_hi:[1,0,1]
    v_pk_fma_f32 v[116:117], v[124:125], v[130:131], v[116:117] op_sel:[0,0,0] op_sel_hi:[1,0,1]
    v_pk_fma_f32 v[118:119], v[126:127], v[130:131], v[118:119] op_sel:[0,0,0] op_sel_hi:[1,0,1]
    v_lshlrev_b32 v120, 16, v144
    v_and_b32 v121, 0xffff0000, v144
    v_lshlrev_b32 v122, 16, v145
    v_and_b32 v123, 0xffff0000, v145
    v_lshlrev_b32 v124, 16, v146
    v_and_b32 v125, 0xffff0000, v146
    v_lshlrev_b32 v126, 16, v147
    v_and_b32 v127, 0xffff0000, v147
    v_pk_fma_f32 v[112:113], v[120:121], v[130:131], v[112:113] op_sel:[0,1,0] op_sel_hi:[1,1,1]
    v_pk_fma_f32 v[114:115], v[122:123], v[130:131], v[114:115] op_sel:[0,1,0] op_sel_hi:[1,1,1]
    v_pk_fma_f32 v[116:117], v[124:125], v[130:131], v[116:117] op_sel:[0,1,0] op_sel_hi:[1,1,1]
    v_pk_fma_f32 v[118:119], v[126:127], v[130:131], v[118:119] op_sel:[0,1,0] op_sel_hi:[1,1,1]
    v_add_f32_dpp v112, v112, v112 row_ror:8 row_mask:0xf bank_mask:0xf
    v_add_f32_dpp v113, v113, v113 row_ror:8 row_mask:0xf bank_mask:0xf
    v_add_f32_dpp v114, v114, v114 row_ror:8 row_mask:0xf bank_mask:0xf
    v_add_f32_dpp v115, v115, v115 row_ror:8 row_mask:0xf bank_mask:0xf
    v_add_f32_dpp v116, v116, v116 row_ror:8 row_mask:0xf bank_mask:0xf
    v_add_f32_dpp v117, v117, v117 row_ror:8 row_mask:0xf bank_mask:0xf
    v_add_f32_dpp v118, v118, v118 row_ror:8 row_mask:0xf bank_mask:0xf
    v_add_f32_dpp v119, v119, v119 row_ror:8 row_mask:0xf bank_mask:0xf
    ds_write_b128 v182, v[112:115] offset:44032
    ds_write_b128 v182, v[116:119] offset:44048
L_b2_done:
    ds_read_u16 v240, v184 offset:0
    ds_read_u16 v248, v184 offset:2064
    ds_read_u16 v241, v184 offset:4128
    ds_read_u16 v249, v184 offset:6192
    ds_read_u16 v242, v184 offset:8256
    ds_read_u16 v250, v184 offset:10320
    ds_read_u16 v243, v184 offset:12384
    ds_read_u16 v251, v184 offset:14448
    s_cmp_lg_u32 s3, 3
    s_cbranch_scc1 L_late1
    s_waitcnt vmcnt(2)
    v_xor_b32 v8, v192, v181
    s_waitcnt vmcnt(1)
    v_bitop3_b32 v8, v193, v181, v8 bitop3:0xbe
    s_waitcnt vmcnt(0)
    v_bitop3_b32 v8, v194, v181, v8 bitop3:0xbe
    v_cmp_ne_u32 vcc, 0, v8
    s_nop 1
    s_cbranch_vccz L_w1ok
    s_mov_b32 s30, 0
L_poll_w1:
    buffer_load_dword v192, v180, s[12:15], 0 offen offset:0 sc1
    buffer_load_dword v193, v180, s[12:15], 0 offen offset:1024 sc1
    buffer_load_dword v194, v180, s[12:15], 0 offen offset:2048 sc1
    s_waitcnt vmcnt(2)
    v_xor_b32 v8, v192, v181
    s_waitcnt vmcnt(1)
    v_bitop3_b32 v8, v193, v181, v8 bitop3:0xbe
    s_waitcnt vmcnt(0)
    v_bitop3_b32 v8, v194, v181, v8 bitop3:0xbe
    v_cmp_ne_u32 vcc, 0, v8
    s_add_u32 s30, s30, 1
    s_cmp_ge_u32 s30, 20000
    s_cbranch_scc1 L_pd_w1
    s_cmp_eq_u64 vcc, 0
    s_cbranch_scc1 L_pd_w1
    s_sleep 2
    s_branch L_poll_w1
L_pd_w1:
L_w1ok:
L_late1:
    s_waitcnt lgkmcnt(8)
    s_barrier
    ds_read_b128 v[24:27], v190 offset:35840
    ds_read_b128 v[28:31], v190 offset:36096
    s_add_u32 s49, s48, 16384
    ds_read_u16 v244, v185 offset:0
    ds_read_u16 v252, v185 offset:2064
    ds_read_u16 v245, v185 offset:4128
    ds_read_u16 v253, v185 offset:6192
    ds_read_u16 v246, v185 offset:8256
    ds_read_u16 v254, v185 offset:10320
    ds_read_u16 v247, v185 offset:12384
    ds_read_u16 v255, v185 offset:14448
    s_waitcnt lgkmcnt(15)
    v_lshl_or_b32 v240, v248, 16, v240
    s_waitcnt lgkmcnt(14)
    v_lshl_or_b32 v241, v249, 16, v241
    s_waitcnt lgkmcnt(12)
    v_lshl_or_b32 v242, v250, 16, v242
    s_waitcnt lgkmcnt(10)
    v_lshl_or_b32 v243, v251, 16, v243
    buffer_store_dwordx4 v[240:243], v188, s[12:15], s45 offen sc1
    s_waitcnt lgkmcnt(9)
    v_mfma_f32_16x16x32_bf16 v[32:35], v[24:27], v[200:203], 0
    v_mfma_f32_16x16x32_bf16 v[36:39], v[24:27], v[204:207], 0
    s_waitcnt lgkmcnt(8)
    v_mfma_f32_16x16x32_bf16 v[40:43], v[28:31], v[200:203], 0
    v_mfma_f32_16x16x32_bf16 v[44:47], v[28:31], v[204:207], 0
    s_nop 4
    v_cvt_pk_bf16_f32 v48, v32, v36
    v_cvt_pk_bf16_f32 v49, v33, v37
    v_cvt_pk_bf16_f32 v50, v34, v38
    v_cvt_pk_bf16_f32 v51, v35, v39
    v_cvt_pk_bf16_f32 v52, v40, v44
    v_cvt_pk_bf16_f32 v53, v41, v45
    v_cvt_pk_bf16_f32 v54, v42, v46
    v_cvt_pk_bf16_f32 v55, v43, v47
    v_mfma_f32_16x16x32_bf16 v[56:59], v[208:211], v[48:51], 0
    v_mfma_f32_16x16x32_bf16 v[60:63], v[224:227], v[48:51], 0
    v_mfma_f32_16x16x32_bf16 v[64:67], v[216:219], v[48:51], 0
    v_mfma_f32_16x16x32_bf16 v[68:71], v[232:235], v[48:51], 0
    v_mfma_f32_16x16x32_bf16 v[56:59], v[212:215], v[52:55], v[56:59]
    v_mfma_f32_16x16x32_bf16 v[60:63], v[228:231], v[52:55], v[60:63]
    v_mfma_f32_16x16x32_bf16 v[64:67], v[220:223], v[52:55], v[64:67]
    v_mfma_f32_16x16x32_bf16 v[68:71], v[236:239], v[52:55], v[68:71]
    s_waitcnt lgkmcnt(6)
    v_lshl_or_b32 v244, v252, 16, v244
    s_waitcnt lgkmcnt(4)
    v_lshl_or_b32 v245, v253, 16, v245
    s_waitcnt lgkmcnt(2)
    v_lshl_or_b32 v246, v254, 16, v246
    s_waitcnt lgkmcnt(0)
    v_lshl_or_b32 v247, v255, 16, v247
    buffer_store_dwordx4 v[244:247], v187, s[12:15], s45 offen sc1
    v_cvt_pk_bf16_f32 v72, v56, v60
    v_cvt_pk_bf16_f32 v73, v57, v61
    v_cvt_pk_bf16_f32 v74, v58, v62
    v_cvt_pk_bf16_f32 v75, v59, v63
    buffer_store_dwordx4 v[72:75], v191, s[12:15], s48 offen sc1
    v_cvt_pk_bf16_f32 v76, v64, v68
    v_cvt_pk_bf16_f32 v77, v65, v69
    v_cvt_pk_bf16_f32 v78, v66, v70
    v_cvt_pk_bf16_f32 v79, v67, v71
    buffer_store_dwordx4 v[76:79], v191, s[12:15], s49 offen sc1
    s_cmp_eq_u32 s43, 0
    s_cbranch_scc1 L_nosp
    s_cmp_lg_u32 s43, 1
    s_cbranch_scc1 L_sp23
    v_xor_b32 v48, 0x80000000, v48
    v_xor_b32 v49, 0x80000000, v49
    v_xor_b32 v50, 0x80000000, v50
    v_xor_b32 v51, 0x80000000, v51
    v_xor_b32 v52, 0x80000000, v52
    v_xor_b32 v53, 0x80000000, v53
    v_xor_b32 v54, 0x80000000, v54
    v_xor_b32 v55, 0x80000000, v55
    s_lshl_b32 s26, s21, 11
    s_add_u32 s26, s26, 393216
    v_mfma_f32_16x16x32_bf16 v[80:83], v[208:211], v[48:51], 0
    v_mfma_f32_16x16x32_bf16 v[84:87], v[224:227], v[48:51], 0
    v_mfma_f32_16x16x32_bf16 v[88:91], v[216:219], v[48:51], 0
    v_mfma_f32_16x16x32_bf16 v[92:95], v[232:235], v[48:51], 0
    v_mfma_f32_16x16x32_bf16 v[80:83], v[212:215], v[52:55], v[80:83]
    v_mfma_f32_16x16x32_bf16 v[84:87], v[228:231], v[52:55], v[84:87]
    v_mfma_f32_16x16x32_bf16 v[88:91], v[220:223], v[52:55], v[88:91]
    v_mfma_f32_16x16x32_bf16 v[92:95], v[236:239], v[52:55], v[92:95]
    s_nop 5
    v_cvt_pk_bf16_f32 v96, v80, v84
    v_cvt_pk_bf16_f32 v97, v81, v85
    v_cvt_pk_bf16_f32 v98, v82, v86
    v_cvt_pk_bf16_f32 v99, v83, v87
    buffer_store_dwordx4 v[96:99], v2, s[12:15], s26 offen offset:0 sc1
    v_cvt_pk_bf16_f32 v100, v88, v92
    v_cvt_pk_bf16_f32 v101, v89, v93
    v_cvt_pk_bf16_f32 v102, v90, v94
    v_cvt_pk_bf16_f32 v103, v91, v95
    buffer_store_dwordx4 v[100:103], v2, s[12:15], s26 offen offset:1024 sc1
    s_branch L_nosp
L_sp23:
    s_cmp_eq_u32 s43, 3
    s_cbranch_scc1 L_sp3
    ds_read_b32 v16, v183 offset:44032
    ds_read_b32 v17, v183 offset:44288
    ds_read_b32 v18, v183 offset:44544
    ds_read_b32 v19, v183 offset:44800
    ds_read_b32 v20, v183 offset:45056
    ds_read_b32 v21, v183 offset:45312
    ds_read_b32 v22, v183 offset:45568
    ds_read_b32 v23, v183 offset:45824
    ds_read_b32 v24, v183 offset:46080
    ds_read_b32 v25, v183 offset:46336
    ds_read_b32 v26, v183 offset:46592
    ds_read_b32 v27, v183 offset:46848
    ds_read_b32 v28, v183 offset:47104
    ds_read_b32 v29, v183 offset:47360
    ds_read_b32 v30, v183 offset:47616
    ds_read_b32 v31, v183 offset:47872
    s_waitcnt lgkmcnt(6)
    v_pk_add_f32 v[16:17], v[16:17], v[24:25]
    s_waitcnt lgkmcnt(4)
    v_pk_add_f32 v[18:19], v[18:19], v[26:27]
    s_waitcnt lgkmcnt(2)
    v_pk_add_f32 v[20:21], v[20:21], v[28:29]
    s_waitcnt lgkmcnt(0)
    v_pk_add_f32 v[22:23], v[22:23], v[30:31]
    v_pk_add_f32 v[16:17], v[16:17], v[20:21]
    v_pk_add_f32 v[18:19], v[18:19], v[22:23]
    v_pk_add_f32 v[16:17], v[16:17], v[18:19]
    v_add_f32 v16, v16, v17
    buffer_store_dword v16, v183, s[12:15], s52 offen sc1
    s_branch L_nosp
L_sp3:
    s_mov_b64 exec, 0xffff
    s_waitcnt vmcnt(6)
    ds_read_u16 v192, v186 offset:0
    s_waitcnt vmcnt(5)
    ds_read_u16 v193, v186 offset:512
    s_waitcnt vmcnt(4)
    ds_read_u16 v194, v186 offset:2064
    ds_read_u16 v195, v186 offset:2576
    s_waitcnt lgkmcnt(3)
    v_lshlrev_b32 v192, 16, v192
    s_waitcnt lgkmcnt(2)
    v_lshlrev_b32 v193, 16, v193
    s_waitcnt lgkmcnt(1)
    v_lshlrev_b32 v194, 16, v194
    s_waitcnt lgkmcnt(0)
    v_lshlrev_b32 v195, 16, v195
    v_lshlrev_b32 v196, 16, v196
    v_lshlrev_b32 v197, 16, v197
    v_lshlrev_b32 v198, 16, v198
    v_lshlrev_b32 v199, 16, v199
    v_add_f32 v192, v192, v196
    v_add_f32 v193, v193, v197
    v_sub_f32 v194, v194, v198
    v_sub_f32 v195, v195, v199
    v_add_f32 v196, v192, v193
    v_add_f32 v197, v194, v195
    v_sub_f32 v198, v192, v193
    v_sub_f32 v199, v194, v195
    v_mul_f32 v196, 0x3e800000, v196
    v_mul_f32 v197, 0x3e800000, v197
    v_mul_f32 v198, 0x3e800000, v198
    v_mul_f32 v199, 0x3e800000, v199
    v_cvt_pk_bf16_f32 v196, v196, v197
    v_cvt_pk_bf16_f32 v198, v198, v199
    v_and_b32 v192, 3, v0
    v_lshlrev_b32 v192, 4, v192
    v_and_b32 v193, 12, v0
    v_add_u32 v192, v192, v193
    buffer_store_dword v196, v192, s[12:15], s53 offen sc1
    buffer_store_dword v198, v192, s[12:15], s54 offen sc1
    s_mov_b64 exec, -1
L_nosp:
    s_load_dwordx16 s[40:55], s[18:19], 192
    s_mov_b64 s[4:5], s[98:99]
    s_mov_b64 s[8:9], s[96:97]
    s_cmp_eq_u32 s3, 3
    s_cselect_b32 s31, 0, 4096
    s_cselect_b32 s60, 158976, s60
    s_and_b32 s26, s3, 1
    s_lshl_b32 s24, s26, 5
    v_lshl_add_u32 v9, v6, 2, s24
    v_cvt_f32_u32 v9, v9
    v_mov_b32 v1, v9
    v_add3_u32 v10, s24, v5, 0
    v_cvt_f32_u32 v10, v10
    v_mul_f32 v12, 0x3c800000, v10
    v_mul_f32 v11, v12, v1
    v_cos_f32 v168, v12
    v_sin_f32 v169, v12
    v_cos_f32 v160, v11
    v_sin_f32 v161, v11
    s_nop 0
    v_pk_mul_f32 v[162:163], v[160:161], v[168:169] op_sel_hi:[1,0]
    v_pk_fma_f32 v[162:163], v[160:161], v[168:169], v[162:163] op_sel:[1,1,0] op_sel_hi:[0,1,1] neg_lo:[1,0,0]
    v_pk_mul_f32 v[164:165], v[162:163], v[168:169] op_sel_hi:[1,0]
    v_pk_fma_f32 v[164:165], v[162:163], v[168:169], v[164:165] op_sel:[1,1,0] op_sel_hi:[0,1,1] neg_lo:[1,0,0]
    v_pk_mul_f32 v[166:167], v[164:165], v[168:169] op_sel_hi:[1,0]
    v_pk_fma_f32 v[166:167], v[164:165], v[168:169], v[166:167] op_sel:[1,1,0] op_sel_hi:[0,1,1] neg_lo:[1,0,0]
    v_cvt_pk_bf16_f32 v64, v160, v161
    v_cvt_pk_bf16_f32 v96, -v161, v160
    buffer_load_dwordx4 a[0:3], v2, s[32:35], s58 offen offset:0 sc1
    v_cvt_pk_bf16_f32 v65, v162, v163
    v_cvt_pk_bf16_f32 v97, -v163, v162
    v_cvt_pk_bf16_f32 v66, v164, v165
    v_cvt_pk_bf16_f32 v98, -v165, v164
    v_cvt_pk_bf16_f32 v67, v166, v167
    v_cvt_pk_bf16_f32 v99, -v167, v166
    v_fmamk_f32 v170, v12, 0x41800000, v11
    v_cos_f32 v160, v170
    v_sin_f32 v161, v170
    s_nop 0
    v_pk_mul_f32 v[162:163], v[160:161], v[168:169] op_sel_hi:[1,0]
    v_pk_fma_f32 v[162:163], v[160:161], v[168:169], v[162:163] op_sel:[1,1,0] op_sel_hi:[0,1,1] neg_lo:[1,0,0]
    v_pk_mul_f32 v[164:165], v[162:163], v[168:169] op_sel_hi:[1,0]
    v_pk_fma_f32 v[164:165], v[162:163], v[168:169], v[164:165] op_sel:[1,1,0] op_sel_hi:[0,1,1] neg_lo:[1,0,0]
    v_pk_mul_f32 v[166:167], v[164:165], v[168:169] op_sel_hi:[1,0]
    v_pk_fma_f32 v[166:167], v[164:165], v[168:169], v[166:167] op_sel:[1,1,0] op_sel_hi:[0,1,1] neg_lo:[1,0,0]
    v_cvt_pk_bf16_f32 v68, v160, v161
    v_cvt_pk_bf16_f32 v100, -v161, v160
    v_cvt_pk_bf16_f32 v69, v162, v163
    v_cvt_pk_bf16_f32 v101, -v163, v162
    v_cvt_pk_bf16_f32 v70, v164, v165
    buffer_load_dwordx4 a[4:7], v2, s[32:35], s58 offen offset:1024 sc1
    v_cvt_pk_bf16_f32 v102, -v165, v164
    v_cvt_pk_bf16_f32 v71, v166, v167
    v_cvt_pk_bf16_f32 v103, -v167, v166
    v_fmamk_f32 v170, v12, 0x42000000, v11
    v_cos_f32 v160, v170
    v_sin_f32 v161, v170
    s_nop 0
    v_pk_mul_f32 v[162:163], v[160:161], v[168:169] op_sel_hi:[1,0]
    v_pk_fma_f32 v[162:163], v[160:161], v[168:169], v[162:163] op_sel:[1,1,0] op_sel_hi:[0,1,1] neg_lo:[1,0,0]
    v_pk_mul_f32 v[164:165], v[162:163], v[168:169] op_sel_hi:[1,0]
    v_pk_fma_f32 v[164:165], v[162:163], v[168:169], v[164:165] op_sel:[1,1,0] op_sel_hi:[0,1,1] neg_lo:[1,0,0]
    v_pk_mul_f32 v[166:167], v[164:165], v[168:169] op_sel_hi:[1,0]
    v_pk_fma_f32 v[166:167], v[164:165], v[168:169], v[166:167] op_sel:[1,1,0] op_sel_hi:[0,1,1] neg_lo:[1,0,0]
    v_cvt_pk_bf16_f32 v72, v160, v161
    v_cvt_pk_bf16_f32 v104, -v161, v160
    v_cvt_pk_bf16_f32 v73, v162, v163
    v_cvt_pk_bf16_f32 v105, -v163, v162
    v_cvt_pk_bf16_f32 v74, v164, v165
    v_cvt_pk_bf16_f32 v106, -v165, v164
    v_cvt_pk_bf16_f32 v75, v166, v167
    v_cvt_pk_bf16_f32 v107, -v167, v166
    v_fmamk_f32 v170, v12, 0x42400000, v11
    buffer_load_dwordx4 a[8:11], v2, s[32:35], s58 offen offset:2048 sc1
    v_cos_f32 v160, v170
    v_sin_f32 v161, v170
    s_nop 0
    v_pk_mul_f32 v[162:163], v[160:161], v[168:169] op_sel_hi:[1,0]
    v_pk_fma_f32 v[162:163], v[160:161], v[168:169], v[162:163] op_sel:[1,1,0] op_sel_hi:[0,1,1] neg_lo:[1,0,0]
    v_pk_mul_f32 v[164:165], v[162:163], v[168:169] op_sel_hi:[1,0]
    v_pk_fma_f32 v[164:165], v[162:163], v[168:169], v[164:165] op_sel:[1,1,0] op_sel_hi:[0,1,1] neg_lo:[1,0,0]
    v_pk_mul_f32 v[166:167], v[164:165], v[168:169] op_sel_hi:[1,0]
    v_pk_fma_f32 v[166:167], v[164:165], v[168:169], v[166:167] op_sel:[1,1,0] op_sel_hi:[0,1,1] neg_lo:[1,0,0]
    v_cvt_pk_bf16_f32 v76, v160, v161
    v_cvt_pk_bf16_f32 v108, -v161, v160
    v_cvt_pk_bf16_f32 v77, v162, v163
    v_cvt_pk_bf16_f32 v109, -v163, v162
    v_cvt_pk_bf16_f32 v78, v164, v165
    v_cvt_pk_bf16_f32 v110, -v165, v164
    v_cvt_pk_bf16_f32 v79, v166, v167
    v_cvt_pk_bf16_f32 v111, -v167, v166
    s_and_b32 s22, s3, 1
    v_lshl_add_u32 v7, s22, 6, v0
    v_lshlrev_b32 v10, 3, v7
    v_lshrrev_b32 v11, 3, v7
    v_mul_u32_u24 v11, 22528, v11
    buffer_load_dwordx4 a[12:15], v2, s[32:35], s58 offen offset:3072 sc1
    s_add_u32 s58, s58, 4096
    v_and_b32 v7, 7, v7
    v_lshl_add_u32 v15, v7, 4, v11
    buffer_load_dwordx4 a[16:19], v2, s[32:35], s58 offen offset:0 sc1
    buffer_load_dwordx4 a[20:23], v2, s[32:35], s58 offen offset:1024 sc1
    buffer_load_dwordx4 a[24:27], v2, s[32:35], s58 offen offset:2048 sc1
    buffer_load_dwordx4 a[28:31], v2, s[32:35], s58 offen offset:3072 sc1
    s_add_u32 s58, s58, 4096
    v_mov_b32 v8, 0
    v_mov_b32 v9, s94
    s_waitcnt vmcnt(8) lgkmcnt(0)
    s_barrier
    s_mov_b64 exec, 1
    buffer_store_dword v9, v8, s[12:15], s61 offen sc1
    s_mov_b64 exec, -1
    s_cmp_lg_u32 s3, 3
    s_cbranch_scc1 L_nt1
    v_lshlrev_b32 v8, 7, v0
    buffer_load_dword v177, v8, s[32:35], s71 offen sc1
    s_add_u32 s71, s71, 8192
    buffer_load_dword v178, v8, s[32:35], s71 offen sc1
    s_add_u32 s71, s71, 8192
    s_mov_b32 exec_hi, 65535
    s_mov_b32 exec_lo, -1
    buffer_load_dword v179, v8, s[32:35], s71 offen sc1
    s_mov_b64 exec, -1
L_nt1:
    s_mov_b32 s6, 1409024
    s_mov_b32 s7, 0x20000
    s_mov_b32 s10, 2752
    s_mov_b32 s11, 0x20000
    v_mov_b32 v13, v10
    v_add3_u32 v10, s24, v5, 16
    v_cvt_f32_u32 v10, v10
    v_mul_f32 v12, 0x3c800000, v10
    v_mul_f32 v11, v12, v1
    v_cos_f32 v168, v12
    v_sin_f32 v169, v12
    v_cos_f32 v160, v11
    v_sin_f32 v161, v11
    s_add_u32 s23, s56, 0
    buffer_load_dwordx2 v[192:193], v13, s[4:7], s23 offen nt
    v_pk_mul_f32 v[162:163], v[160:161], v[168:169] op_sel_hi:[1,0]
    v_pk_fma_f32 v[162:163], v[160:161], v[168:169], v[162:163] op_sel:[1,1,0] op_sel_hi:[0,1,1] neg_lo:[1,0,0]
    v_pk_mul_f32 v[164:165], v[162:163], v[168:169] op_sel_hi:[1,0]
    v_pk_fma_f32 v[164:165], v[162:163], v[168:169], v[164:165] op_sel:[1,1,0] op_sel_hi:[0,1,1] neg_lo:[1,0,0]
    v_pk_mul_f32 v[166:167], v[164:165], v[168:169] op_sel_hi:[1,0]
    v_pk_fma_f32 v[166:167], v[164:165], v[168:169], v[166:167] op_sel:[1,1,0] op_sel_hi:[0,1,1] neg_lo:[1,0,0]
    v_cvt_pk_bf16_f32 v80, v160, v161
    v_cvt_pk_bf16_f32 v112, -v161, v160
    v_cvt_pk_bf16_f32 v81, v162, v163
    v_cvt_pk_bf16_f32 v113, -v163, v162
    v_cvt_pk_bf16_f32 v82, v164, v165
    s_add_u32 s23, s56, 4096
    buffer_load_dwordx2 v[194:195], v13, s[4:7], s23 offen nt
    v_cvt_pk_bf16_f32 v114, -v165, v164
    v_cvt_pk_bf16_f32 v83, v166, v167
    v_cvt_pk_bf16_f32 v115, -v167, v166
    v_fmamk_f32 v170, v12, 0x41800000, v11
    v_cos_f32 v160, v170
    v_sin_f32 v161, v170
    s_nop 0
    v_pk_mul_f32 v[162:163], v[160:161], v[168:169] op_sel_hi:[1,0]
    v_pk_fma_f32 v[162:163], v[160:161], v[168:169], v[162:163] op_sel:[1,1,0] op_sel_hi:[0,1,1] neg_lo:[1,0,0]
    v_pk_mul_f32 v[164:165], v[162:163], v[168:169] op_sel_hi:[1,0]
    s_add_u32 s23, s56, 8192
    buffer_load_dwordx2 v[196:197], v13, s[4:7], s23 offen nt
    v_pk_fma_f32 v[164:165], v[162:163], v[168:169], v[164:165] op_sel:[1,1,0] op_sel_hi:[0,1,1] neg_lo:[1,0,0]
    v_pk_mul_f32 v[166:167], v[164:165], v[168:169] op_sel_hi:[1,0]
    v_pk_fma_f32 v[166:167], v[164:165], v[168:169], v[166:167] op_sel:[1,1,0] op_sel_hi:[0,1,1] neg_lo:[1,0,0]
    v_cvt_pk_bf16_f32 v84, v160, v161
    v_cvt_pk_bf16_f32 v116, -v161, v160
    v_cvt_pk_bf16_f32 v85, v162, v163
    v_cvt_pk_bf16_f32 v117, -v163, v162
    v_cvt_pk_bf16_f32 v86, v164, v165
    v_cvt_pk_bf16_f32 v118, -v165, v164
    v_cvt_pk_bf16_f32 v87, v166, v167
    v_cvt_pk_bf16_f32 v119, -v167, v166
    s_add_u32 s23, s56, 12288
    buffer_load_dwordx2 v[198:199], v13, s[4:7], s23 offen nt
    v_fmamk_f32 v170, v12, 0x42000000, v11
    v_cos_f32 v160, v170
    v_sin_f32 v161, v170
    s_nop 0
    v_pk_mul_f32 v[162:163], v[160:161], v[168:169] op_sel_hi:[1,0]
    v_pk_fma_f32 v[162:163], v[160:161], v[168:169], v[162:163] op_sel:[1,1,0] op_sel_hi:[0,1,1] neg_lo:[1,0,0]
    v_pk_mul_f32 v[164:165], v[162:163], v[168:169] op_sel_hi:[1,0]
    v_pk_fma_f32 v[164:165], v[162:163], v[168:169], v[164:165] op_sel:[1,1,0] op_sel_hi:[0,1,1] neg_lo:[1,0,0]
    v_pk_mul_f32 v[166:167], v[164:165], v[168:169] op_sel_hi:[1,0]
    v_pk_fma_f32 v[166:167], v[164:165], v[168:169], v[166:167] op_sel:[1,1,0] op_sel_hi:[0,1,1] neg_lo:[1,0,0]
    v_cvt_pk_bf16_f32 v88, v160, v161
    s_add_u32 s23, s56, 1024
    buffer_load_dwordx2 v[200:201], v13, s[4:7], s23 offen nt
    v_cvt_pk_bf16_f32 v120, -v161, v160
    v_cvt_pk_bf16_f32 v89, v162, v163
    v_cvt_pk_bf16_f32 v121, -v163, v162
    v_cvt_pk_bf16_f32 v90, v164, v165
    v_cvt_pk_bf16_f32 v122, -v165, v164
    v_cvt_pk_bf16_f32 v91, v166, v167
    v_cvt_pk_bf16_f32 v123, -v167, v166
    v_fmamk_f32 v170, v12, 0x42400000, v11
    v_cos_f32 v160, v170
    v_sin_f32 v161, v170
    s_add_u32 s23, s56, 5120
    buffer_load_dwordx2 v[202:203], v13, s[4:7], s23 offen nt
    v_pk_mul_f32 v[162:163], v[160:161], v[168:169] op_sel_hi:[1,0]
    v_pk_fma_f32 v[162:163], v[160:161], v[168:169], v[162:163] op_sel:[1,1,0] op_sel_hi:[0,1,1] neg_lo:[1,0,0]
    v_pk_mul_f32 v[164:165], v[162:163], v[168:169] op_sel_hi:[1,0]
    v_pk_fma_f32 v[164:165], v[162:163], v[168:169], v[164:165] op_sel:[1,1,0] op_sel_hi:[0,1,1] neg_lo:[1,0,0]
    v_pk_mul_f32 v[166:167], v[164:165], v[168:169] op_sel_hi:[1,0]
    v_pk_fma_f32 v[166:167], v[164:165], v[168:169], v[166:167] op_sel:[1,1,0] op_sel_hi:[0,1,1] neg_lo:[1,0,0]
    v_cvt_pk_bf16_f32 v92, v160, v161
    v_cvt_pk_bf16_f32 v124, -v161, v160
    v_cvt_pk_bf16_f32 v93, v162, v163
    v_cvt_pk_bf16_f32 v125, -v163, v162
    s_add_u32 s23, s56, 9216
    buffer_load_dwordx2 v[204:205], v13, s[4:7], s23 offen nt
    v_cvt_pk_bf16_f32 v94, v164, v165
    v_cvt_pk_bf16_f32 v126, -v165, v164
    v_cvt_pk_bf16_f32 v95, v166, v167
    v_cvt_pk_bf16_f32 v127, -v167, v166
    v_lshlrev_b32 v11, 2, v6
    v_cvt_f32_u32 v11, v11
    v_lshl_add_u32 v9, v5, 6, s21
    v_add_u32 v9, 0, v9
    v_cvt_f32_u32 v9, v9
    v_mul_f32 v10, 0x3a000000, v9
    v_mul_f32 v9, v11, v10
    s_add_u32 s23, s56, 13312
    buffer_load_dwordx2 v[206:207], v13, s[4:7], s23 offen nt
    v_cos_f32 v168, v10
    v_sin_f32 v169, v10
    v_cos_f32 v160, v9
    v_sin_f32 v161, v9
    s_nop 0
    v_pk_mul_f32 v[162:163], v[160:161], v[168:169] op_sel_hi:[1,0]
    v_pk_fma_f32 v[162:163], v[160:161], v[168:169], v[162:163] op_sel:[1,1,0] op_sel_hi:[0,1,1] neg_lo:[1,0,0]
    v_pk_mul_f32 v[164:165], v[162:163], v[168:169] op_sel_hi:[1,0]
    v_pk_fma_f32 v[164:165], v[162:163], v[168:169], v[164:165] op_sel:[1,1,0] op_sel_hi:[0,1,1] neg_lo:[1,0,0]
    buffer_load_dwordx4 a[32:35], v2, s[32:35], s58 offen offset:0 sc1
    v_pk_mul_f32 v[166:167], v[164:165], v[168:169] op_sel_hi:[1,0]
    v_pk_fma_f32 v[166:167], v[164:165], v[168:169], v[166:167] op_sel:[1,1,0] op_sel_hi:[0,1,1] neg_lo:[1,0,0]
    v_cvt_pk_bf16_f32 v224, v160, -v161
    v_cvt_pk_bf16_f32 v240, v161, v160
    v_cvt_pk_bf16_f32 v225, v162, -v163
    v_cvt_pk_bf16_f32 v241, v163, v162
    v_cvt_pk_bf16_f32 v226, v164, -v165
    v_cvt_pk_bf16_f32 v242, v165, v164
    v_cvt_pk_bf16_f32 v227, v166, -v167
    v_cvt_pk_bf16_f32 v243, v167, v166
    v_fmamk_f32 v170, v10, 0x41800000, v9
    buffer_load_dwordx4 a[36:39], v2, s[32:35], s58 offen offset:1024 sc1
    v_cos_f32 v160, v170
    v_sin_f32 v161, v170
    s_nop 0
    v_pk_mul_f32 v[162:163], v[160:161], v[168:169] op_sel_hi:[1,0]
    v_pk_fma_f32 v[162:163], v[160:161], v[168:169], v[162:163] op_sel:[1,1,0] op_sel_hi:[0,1,1] neg_lo:[1,0,0]
    v_pk_mul_f32 v[164:165], v[162:163], v[168:169] op_sel_hi:[1,0]
    v_pk_fma_f32 v[164:165], v[162:163], v[168:169], v[164:165] op_sel:[1,1,0] op_sel_hi:[0,1,1] neg_lo:[1,0,0]
    v_pk_mul_f32 v[166:167], v[164:165], v[168:169] op_sel_hi:[1,0]
    v_pk_fma_f32 v[166:167], v[164:165], v[168:169], v[166:167] op_sel:[1,1,0] op_sel_hi:[0,1,1] neg_lo:[1,0,0]
    v_cvt_pk_bf16_f32 v228, v160, -v161
    buffer_load_dwordx4 a[40:43], v2, s[32:35], s58 offen offset:2048 sc1
    v_cvt_pk_bf16_f32 v244, v161, v160
    v_cvt_pk_bf16_f32 v229, v162, -v163
    v_cvt_pk_bf16_f32 v245, v163, v162
    v_cvt_pk_bf16_f32 v230, v164, -v165
    v_cvt_pk_bf16_f32 v246, v165, v164
    v_cvt_pk_bf16_f32 v231, v166, -v167
    v_cvt_pk_bf16_f32 v247, v167, v166
    v_lshl_add_u32 v9, v5, 6, s21
    v_add_u32 v9, 1024, v9
    v_cvt_f32_u32 v9, v9
    v_mul_f32 v10, 0x3a000000, v9
    buffer_load_dwordx4 a[44:47], v2, s[32:35], s58 offen offset:3072 sc1
    s_add_u32 s58, s58, 4096
    v_mul_f32 v9, v11, v10
    v_cos_f32 v168, v10
    v_sin_f32 v169, v10
    v_cos_f32 v160, v9
    v_sin_f32 v161, v9
    s_nop 0
    v_pk_mul_f32 v[162:163], v[160:161], v[168:169] op_sel_hi:[1,0]
    v_pk_fma_f32 v[162:163], v[160:161], v[168:169], v[162:163] op_sel:[1,1,0] op_sel_hi:[0,1,1] neg_lo:[1,0,0]
    v_pk_mul_f32 v[164:165], v[162:163], v[168:169] op_sel_hi:[1,0]
    buffer_load_dwordx4 a[48:51], v2, s[32:35], s58 offen offset:0 sc1
    v_pk_fma_f32 v[164:165], v[162:163], v[168:169], v[164:165] op_sel:[1,1,0] op_sel_hi:[0,1,1] neg_lo:[1,0,0]
    v_pk_mul_f32 v[166:167], v[164:165], v[168:169] op_sel_hi:[1,0]
    v_pk_fma_f32 v[166:167], v[164:165], v[168:169], v[166:167] op_sel:[1,1,0] op_sel_hi:[0,1,1] neg_lo:[1,0,0]
    v_cvt_pk_bf16_f32 v232, v160, -v161
    v_cvt_pk_bf16_f32 v248, v161, v160
    v_cvt_pk_bf16_f32 v233, v162, -v163
    v_cvt_pk_bf16_f32 v249, v163, v162
    v_cvt_pk_bf16_f32 v234, v164, -v165
    v_cvt_pk_bf16_f32 v250, v165, v164
    v_cvt_pk_bf16_f32 v235, v166, -v167
    v_cvt_pk_bf16_f32 v251, v167, v166
    buffer_load_dwordx4 a[52:55], v2, s[32:35], s58 offen offset:1024 sc1
    v_fmamk_f32 v170, v10, 0x41800000, v9
    v_cos_f32 v160, v170
    v_sin_f32 v161, v170
    s_nop 0
    v_pk_mul_f32 v[162:163], v[160:161], v[168:169] op_sel_hi:[1,0]
    v_pk_fma_f32 v[162:163], v[160:161], v[168:169], v[162:163] op_sel:[1,1,0] op_sel_hi:[0,1,1] neg_lo:[1,0,0]
    v_pk_mul_f32 v[164:165], v[162:163], v[168:169] op_sel_hi:[1,0]
    v_pk_fma_f32 v[164:165], v[162:163], v[168:169], v[164:165] op_sel:[1,1,0] op_sel_hi:[0,1,1] neg_lo:[1,0,0]
    v_pk_mul_f32 v[166:167], v[164:165], v[168:169] op_sel_hi:[1,0]
    v_pk_fma_f32 v[166:167], v[164:165], v[168:169], v[166:167] op_sel:[1,1,0] op_sel_hi:[0,1,1] neg_lo:[1,0,0]
    buffer_load_dwordx4 a[56:59], v2, s[32:35], s58 offen offset:2048 sc1
    v_cvt_pk_bf16_f32 v236, v160, -v161
    v_cvt_pk_bf16_f32 v252, v161, v160
    v_cvt_pk_bf16_f32 v237, v162, -v163
    v_cvt_pk_bf16_f32 v253, v163, v162
    v_cvt_pk_bf16_f32 v238, v164, -v165
    v_cvt_pk_bf16_f32 v254, v165, v164
    v_cvt_pk_bf16_f32 v239, v166, -v167
    v_cvt_pk_bf16_f32 v255, v167, v166
    buffer_load_dwordx4 a[60:63], v2, s[32:35], s58 offen offset:3072 sc1
    s_add_u32 s58, s58, 4096
    buffer_load_dwordx4 a[64:67], v2, s[32:35], s58 offen offset:0 sc1
    buffer_load_dwordx4 a[68:71], v2, s[32:35], s58 offen offset:1024 sc1
    buffer_load_dwordx4 a[72:75], v2, s[32:35], s58 offen offset:2048 sc1
    buffer_load_dwordx4 a[76:79], v2, s[32:35], s58 offen offset:3072 sc1
    s_add_u32 s58, s58, 4096
    v_lshlrev_b32 v7, 17, v6
    v_lshl_add_u32 v7, v5, 2, v7
    v_lshlrev_b32 v13, 15, v5
    v_lshl_add_u32 v13, v6, 4, v13
    v_lshlrev_b32 v14, 1, v2
    s_cmp_eq_u32 s3, 3
    s_cselect_b32 s0, 0, 2147483392
    s_add_u32 s0, s0, 262144
    s_add_u32 s95, s0, 4096
    buffer_load_dword v172, v14, s[12:15], s0 offen offset:0 sc1
    buffer_load_dword v173, v14, s[12:15], s0 offen offset:2048 sc1
    buffer_load_dword v174, v14, s[12:15], s95 offen offset:0 sc1
    buffer_load_dword v175, v14, s[12:15], s95 offen offset:2048 sc1
    buffer_load_dwordx4 a[80:83], v2, s[32:35], s58 offen offset:0 sc1
    buffer_load_dwordx4 a[84:87], v2, s[32:35], s58 offen offset:1024 sc1
    buffer_load_dwordx4 a[88:91], v2, s[32:35], s58 offen offset:2048 sc1
    buffer_load_dwordx4 a[92:95], v2, s[32:35], s58 offen offset:3072 sc1
    s_add_u32 s58, s58, 4096
    buffer_load_dwordx4 a[96:99], v2, s[32:35], s58 offen offset:0 sc1
    buffer_load_dwordx4 a[100:103], v2, s[32:35], s58 offen offset:1024 sc1
    buffer_load_dwordx4 a[104:107], v2, s[32:35], s58 offen offset:2048 sc1
    buffer_load_dwordx4 a[108:111], v2, s[32:35], s58 offen offset:3072 sc1
    s_add_u32 s58, s58, 4096
    buffer_load_dwordx4 a[112:115], v2, s[32:35], s58 offen offset:0 sc1
    buffer_load_dwordx4 a[116:119], v2, s[32:35], s58 offen offset:1024 sc1
    buffer_load_dwordx4 a[120:123], v2, s[32:35], s58 offen offset:2048 sc1
    s_cmp_lg_u32 s3, 3
    s_cbranch_scc1 L_bur_h1
    s_waitcnt vmcnt(14)
    v_xor_b32 v9, s94, v172
    s_waitcnt vmcnt(13)
    v_bitop3_b32 v9, v173, s94, v9 bitop3:0xbe
    s_waitcnt vmcnt(12)
    v_bitop3_b32 v9, v174, s94, v9 bitop3:0xbe
    s_waitcnt vmcnt(11)
    v_bitop3_b32 v9, v175, s94, v9 bitop3:0xbe
    v_cmp_ne_u32 vcc, 0, v9
    s_nop 1
    s_cbranch_vccz L_rel_h1
    s_mov_b32 s30, 0
L_poll_h1:
    s_mov_b64 exec, vcc
    buffer_load_dword v172, v14, s[12:15], s0 offen offset:0 sc1
    buffer_load_dword v173, v14, s[12:15], s0 offen offset:2048 sc1
    buffer_load_dword v174, v14, s[12:15], s95 offen offset:0 sc1
    buffer_load_dword v175, v14, s[12:15], s95 offen offset:2048 sc1
    s_waitcnt vmcnt(3)
    v_xor_b32 v9, s94, v172
    s_waitcnt vmcnt(2)
    v_bitop3_b32 v9, v173, s94, v9 bitop3:0xbe
    s_waitcnt vmcnt(1)
    v_bitop3_b32 v9, v174, s94, v9 bitop3:0xbe
    s_waitcnt vmcnt(0)
    v_bitop3_b32 v9, v175, s94, v9 bitop3:0xbe
    v_cmp_ne_u32 vcc, 0, v9
    s_add_u32 s30, s30, 1
    s_cmp_ge_u32 s30, 20000
    s_cbranch_scc1 L_pd_h1
    s_cmp_eq_u64 vcc, 0
    s_cbranch_scc1 L_pd_h1
    s_sleep 6
    s_branch L_poll_h1
L_pd_h1:
    s_mov_b64 exec, -1
    s_branch L_rel_h1
L_bur_h1:
    s_mov_b32 m0, s60
    s_nop 0
    buffer_load_dwordx4 v2, s[32:35], s59 offen offset:0 sc1 lds
    s_mov_b32 m0, s60
    s_nop 0
    buffer_load_dwordx4 v2, s[32:35], s59 offen offset:1024 sc1 lds
    s_mov_b32 m0, s60
    s_nop 0
    buffer_load_dwordx4 v2, s[32:35], s59 offen offset:2048 sc1 lds
    s_mov_b32 m0, s60
    s_nop 0
    buffer_load_dwordx4 v2, s[32:35], s59 offen offset:3072 sc1 lds
    s_add_u32 s59, s59, s31
    s_add_u32 s60, s60, s31
    s_mov_b32 m0, s60
    s_nop 0
    buffer_load_dwordx4 v2, s[32:35], s59 offen offset:0 sc1 lds
    s_mov_b32 m0, s60
    s_nop 0
    buffer_load_dwordx4 v2, s[32:35], s59 offen offset:1024 sc1 lds
    s_mov_b32 m0, s60
    s_nop 0
    buffer_load_dwordx4 v2, s[32:35], s59 offen offset:2048 sc1 lds
    s_mov_b32 m0, s60
    s_nop 0
    buffer_load_dwordx4 v2, s[32:35], s59 offen offset:3072 sc1 lds
    s_add_u32 s59, s59, s31
    s_add_u32 s60, s60, s31
    s_mov_b32 m0, s60
    s_nop 0
    buffer_load_dwordx4 v2, s[32:35], s59 offen offset:0 sc1 lds
    s_mov_b32 m0, s60
    s_nop 0
    buffer_load_dwordx4 v2, s[32:35], s59 offen offset:1024 sc1 lds
    s_mov_b32 m0, s60
    s_nop 0
    buffer_load_dwordx4 v2, s[32:35], s59 offen offset:2048 sc1 lds
    s_mov_b32 m0, s60
    s_nop 0
    buffer_load_dwordx4 v2, s[32:35], s59 offen offset:3072 sc1 lds
    s_add_u32 s59, s59, s31
    s_add_u32 s60, s60, s31
    s_mov_b32 m0, s60
    s_nop 0
    buffer_load_dwordx4 v2, s[32:35], s59 offen offset:0 sc1 lds
    s_mov_b32 m0, s60
    s_nop 0
    buffer_load_dwordx4 v2, s[32:35], s59 offen offset:1024 sc1 lds
L_rel_h1:
    s_barrier
    buffer_load_dword v16, v7, s[12:15], s62 offen sc1
    s_add_u32 s24, s62, 32768
    buffer_load_dword v17, v7, s[12:15], s24 offen sc1
    s_add_u32 s24, s62, 65536
    buffer_load_dword v18, v7, s[12:15], s24 offen sc1
    s_add_u32 s24, s62, 98304
    buffer_load_dword v19, v7, s[12:15], s24 offen sc1
    s_add_u32 s24, s62, 524288
    buffer_load_dword v20, v7, s[12:15], s24 offen sc1
    s_add_u32 s24, s62, 557056
    buffer_load_dword v21, v7, s[12:15], s24 offen sc1
    s_add_u32 s24, s62, 589824
    buffer_load_dword v22, v7, s[12:15], s24 offen sc1
    s_add_u32 s24, s62, 622592
    buffer_load_dword v23, v7, s[12:15], s24 offen sc1
    buffer_load_dword v24, v7, s[12:15], s63 offen sc1
    s_add_u32 s24, s63, 32768
    buffer_load_dword v25, v7, s[12:15], s24 offen sc1
    s_add_u32 s24, s63, 65536
    buffer_load_dword v26, v7, s[12:15], s24 offen sc1
    s_add_u32 s24, s63, 98304
    buffer_load_dword v27, v7, s[12:15], s24 offen sc1
    s_add_u32 s24, s63, 524288
    buffer_load_dword v28, v7, s[12:15], s24 offen sc1
    s_add_u32 s24, s63, 557056
    buffer_load_dword v29, v7, s[12:15], s24 offen sc1
    s_add_u32 s24, s63, 589824
    buffer_load_dword v30, v7, s[12:15], s24 offen sc1
    s_add_u32 s24, s63, 622592
    buffer_load_dword v31, v7, s[12:15], s24 offen sc1
    buffer_load_dwordx4 v[48:51], v2, s[12:15], s65 offen sc1
    buffer_load_dwordx4 v[52:55], v2, s[12:15], s65 offen offset:1024 sc1
    s_cmp_lg_u32 s66, 0
    s_cbranch_scc1 L_sp1
    v_lshlrev_b32 v8, 13, v6
    v_lshl_add_u32 v8, v5, 2, v8
    v_lshlrev_b32 v9, 6, v6
    v_lshl_add_u32 v9, v5, 4, v9
    v_mov_b32 v10, 2147483392
    v_cmp_gt_u32 vcc, 4, v5
    s_nop 1
    v_cndmask_b32 v8, v10, v8, vcc
    v_cndmask_b32 v9, v10, v9, vcc
    s_add_u32 s24, s68, 0
    buffer_load_dword v32, v8, s[12:15], s24 offen offset:0 sc1
    buffer_load_dword v33, v8, s[12:15], s24 offen offset:2048 sc1
    s_add_u32 s24, s68, 4096
    buffer_load_dword v34, v8, s[12:15], s24 offen offset:0 sc1
    buffer_load_dword v35, v8, s[12:15], s24 offen offset:2048 sc1
    s_add_u32 s24, s68, 32768
    buffer_load_dword v36, v8, s[12:15], s24 offen offset:0 sc1
    buffer_load_dword v37, v8, s[12:15], s24 offen offset:2048 sc1
    s_add_u32 s24, s68, 36864
    buffer_load_dword v38, v8, s[12:15], s24 offen offset:0 sc1
    buffer_load_dword v39, v8, s[12:15], s24 offen offset:2048 sc1
    s_add_u32 s24, s69, 0
    buffer_load_dword v40, v8, s[12:15], s24 offen offset:0 sc1
    buffer_load_dword v41, v8, s[12:15], s24 offen offset:2048 sc1
    s_add_u32 s24, s69, 4096
    buffer_load_dword v42, v8, s[12:15], s24 offen offset:0 sc1
    buffer_load_dword v43, v8, s[12:15], s24 offen offset:2048 sc1
    s_add_u32 s24, s69, 32768
    buffer_load_dword v44, v8, s[12:15], s24 offen offset:0 sc1
    buffer_load_dword v45, v8, s[12:15], s24 offen offset:2048 sc1
    s_add_u32 s24, s69, 36864
    buffer_load_dword v46, v8, s[12:15], s24 offen offset:0 sc1
    buffer_load_dword v47, v8, s[12:15], s24 offen offset:2048 sc1
    buffer_load_dwordx4 v[56:59], v9, s[12:15], s70 offen sc1
    buffer_load_dwordx4 v[60:63], v9, s[12:15], s70 offen offset:256 sc1
L_sp1:
    s_mov_b32 s22, 0x05040100
    s_mov_b32 s23, 0x07060302
    s_waitcnt vmcnt(51)
    v_perm_b32 v208, v194, v192, s22
    s_waitcnt vmcnt(49)
    v_perm_b32 v209, v198, v196, s22
    s_waitcnt vmcnt(47)
    v_perm_b32 v210, v202, v200, s22
    s_waitcnt vmcnt(45)
    v_perm_b32 v211, v206, v204, s22
    v_perm_b32 v212, v194, v192, s23
    v_perm_b32 v213, v198, v196, s23
    v_perm_b32 v214, v202, v200, s23
    v_perm_b32 v215, v206, v204, s23
    v_perm_b32 v216, v195, v193, s22
    v_perm_b32 v217, v199, v197, s22
    v_perm_b32 v218, v203, v201, s22
    v_perm_b32 v219, v207, v205, s22
    v_perm_b32 v220, v195, v193, s23
    v_perm_b32 v221, v199, v197, s23
    v_perm_b32 v222, v203, v201, s23
    v_perm_b32 v223, v207, v205, s23
    s_add_u32 s24, s67, 0
    buffer_load_dwordx4 v[192:195], v2, s[12:15], s24 offen offset:0 sc1
    buffer_load_dwordx4 v[160:163], v2, s[12:15], s24 offen offset:1024 sc1
    s_add_u32 s24, s67, 12288
    buffer_load_dwordx4 v[196:199], v2, s[12:15], s24 offen offset:0 sc1
    buffer_load_dwordx4 v[164:167], v2, s[12:15], s24 offen offset:1024 sc1
    s_add_u32 s24, s67, 24576
    buffer_load_dwordx4 v[200:203], v2, s[12:15], s24 offen offset:0 sc1
    buffer_load_dwordx4 v[168:171], v2, s[12:15], s24 offen offset:1024 sc1
    s_add_u32 s24, s67, 36864
    buffer_load_dwordx4 v[204:207], v2, s[12:15], s24 offen offset:0 sc1
    s_waitcnt vmcnt(36)
    buffer_load_dwordx4 v[172:175], v2, s[12:15], s24 offen offset:1024 sc1
    v_lshl_add_u32 v14, s3, 11, v2
    v_xor_b32 v9, 2048, v14
    s_add_u32 s65, s64, 524288
    s_waitcnt vmcnt(22)
    v_mfma_f32_16x16x32_bf16 v[128:131], v[64:67], v[16:19], 0
    v_mfma_f32_16x16x32_bf16 v[132:135], v[96:99], v[16:19], 0
    v_mfma_f32_16x16x32_bf16 v[136:139], v[80:83], v[16:19], 0
    v_mfma_f32_16x16x32_bf16 v[140:143], v[112:115], v[16:19], 0
    s_waitcnt vmcnt(18)
    v_mfma_f32_16x16x32_bf16 v[128:131], v[68:71], v[20:23], v[128:131]
    v_mfma_f32_16x16x32_bf16 v[132:135], v[100:103], v[20:23], v[132:135]
    buffer_store_dwordx4 v[208:211], v15, s[12:15], s57 offen offset:0 sc1
    v_mfma_f32_16x16x32_bf16 v[136:139], v[84:87], v[20:23], v[136:139]
    v_mfma_f32_16x16x32_bf16 v[140:143], v[116:119], v[20:23], v[140:143]
    s_waitcnt vmcnt(15)
    v_mfma_f32_16x16x32_bf16 v[128:131], v[72:75], v[24:27], v[128:131]
    buffer_store_dwordx4 v[212:215], v15, s[12:15], s57 offen offset:128 sc1
    v_mfma_f32_16x16x32_bf16 v[132:135], v[104:107], v[24:27], v[132:135]
    v_mfma_f32_16x16x32_bf16 v[136:139], v[88:91], v[24:27], v[136:139]
    v_mfma_f32_16x16x32_bf16 v[140:143], v[120:123], v[24:27], v[140:143]
    buffer_store_dwordx4 v[216:219], v15, s[12:15], s57 offen offset:256 sc1
    s_waitcnt vmcnt(13)
    v_mfma_f32_16x16x32_bf16 v[128:131], v[76:79], v[28:31], v[128:131]
    v_mfma_f32_16x16x32_bf16 v[132:135], v[108:111], v[28:31], v[132:135]
    v_mfma_f32_16x16x32_bf16 v[136:139], v[92:95], v[28:31], v[136:139]
    buffer_store_dwordx4 v[220:223], v15, s[12:15], s57 offen offset:384 sc1
    v_mfma_f32_16x16x32_bf16 v[140:143], v[124:127], v[28:31], v[140:143]
    s_cmp_eq_u32 s66, 0
    s_cbranch_scc1 L_sp2
L_sp2_back:
    s_waitcnt vmcnt(13)
    v_lshlrev_b32 v16, 16, v48
    v_and_b32 v17, 0xffff0000, v48
    v_lshlrev_b32 v18, 16, v49
    v_and_b32 v19, 0xffff0000, v49
    v_lshlrev_b32 v20, 16, v50
    v_and_b32 v21, 0xffff0000, v50
    v_lshlrev_b32 v22, 16, v51
    v_and_b32 v23, 0xffff0000, v51
    s_waitcnt vmcnt(12)
    v_lshlrev_b32 v24, 16, v52
    v_and_b32 v25, 0xffff0000, v52
    v_lshlrev_b32 v26, 16, v53
    v_and_b32 v27, 0xffff0000, v53
    v_lshlrev_b32 v28, 16, v54
    v_and_b32 v29, 0xffff0000, v54
    v_lshlrev_b32 v30, 16, v55
    v_and_b32 v31, 0xffff0000, v55
    v_mul_f32 v176, v128, v16
    v_mul_f32 v177, v128, v17
    v_fma_f32 v176, -v132, v17, v176
    v_fmac_f32 v177, v132, v16
    v_mul_f32 v178, v129, v18
    v_mul_f32 v179, v129, v19
    v_fma_f32 v178, -v133, v19, v178
    v_fmac_f32 v179, v133, v18
    v_mul_f32 v180, v130, v20
    v_mul_f32 v181, v130, v21
    v_fma_f32 v180, -v134, v21, v180
    v_fmac_f32 v181, v134, v20
    v_mul_f32 v182, v131, v22
    v_mul_f32 v183, v131, v23
    v_fma_f32 v182, -v135, v23, v182
    v_fmac_f32 v183, v135, v22
    v_mul_f32 v184, v136, v24
    v_mul_f32 v185, v136, v25
    v_fma_f32 v184, -v140, v25, v184
    v_fmac_f32 v185, v140, v24
    v_mul_f32 v186, v137, v26
    v_mul_f32 v187, v137, v27
    v_fma_f32 v186, -v141, v27, v186
    v_fmac_f32 v187, v141, v26
    v_mul_f32 v188, v138, v28
    v_mul_f32 v189, v138, v29
    v_fma_f32 v188, -v142, v29, v188
    v_fmac_f32 v189, v142, v28
    v_mul_f32 v190, v139, v30
    v_mul_f32 v191, v139, v31
    v_fma_f32 v190, -v143, v31, v190
    v_fmac_f32 v191, v143, v30
L_sp2e:
    v_cvt_pk_bf16_f32 v16, v176, -v177
    v_cvt_pk_bf16_f32 v17, v178, -v179
    v_cvt_pk_bf16_f32 v18, v180, -v181
    v_cvt_pk_bf16_f32 v19, v182, -v183
    ds_write_b128 v14, v[16:19] offset:35840
    v_cvt_pk_bf16_f32 v20, v184, -v185
    v_cvt_pk_bf16_f32 v21, v186, -v187
    v_cvt_pk_bf16_f32 v22, v188, -v189
    v_cvt_pk_bf16_f32 v23, v190, -v191
    ds_write_b128 v14, v[20:23] offset:36864
    v_mfma_f32_16x16x32_bf16 v[128:131], v[16:19], v[64:67], 0
    v_mfma_f32_16x16x32_bf16 v[132:135], v[16:19], v[96:99], 0
    v_mfma_f32_16x16x32_bf16 v[136:139], v[16:19], v[80:83], 0
    v_mfma_f32_16x16x32_bf16 v[140:143], v[16:19], v[112:115], 0
    s_waitcnt lgkmcnt(0)
    s_barrier
    ds_read_b128 v[24:27], v9 offset:35840
    ds_read_b128 v[28:31], v9 offset:36864
    v_mfma_f32_16x16x32_bf16 v[128:131], v[20:23], v[68:71], v[128:131]
    v_mfma_f32_16x16x32_bf16 v[132:135], v[20:23], v[100:103], v[132:135]
    v_mfma_f32_16x16x32_bf16 v[136:139], v[20:23], v[84:87], v[136:139]
    v_mfma_f32_16x16x32_bf16 v[140:143], v[20:23], v[116:119], v[140:143]
    s_waitcnt lgkmcnt(1)
    v_mfma_f32_16x16x32_bf16 v[128:131], v[24:27], v[72:75], v[128:131]
    v_mfma_f32_16x16x32_bf16 v[132:135], v[24:27], v[104:107], v[132:135]
    v_mfma_f32_16x16x32_bf16 v[136:139], v[24:27], v[88:91], v[136:139]
    v_mfma_f32_16x16x32_bf16 v[140:143], v[24:27], v[120:123], v[140:143]
    s_waitcnt lgkmcnt(0)
    v_mfma_f32_16x16x32_bf16 v[128:131], v[28:31], v[76:79], v[128:131]
    v_mfma_f32_16x16x32_bf16 v[132:135], v[28:31], v[108:111], v[132:135]
    v_mfma_f32_16x16x32_bf16 v[136:139], v[28:31], v[92:95], v[136:139]
    v_mfma_f32_16x16x32_bf16 v[140:143], v[28:31], v[124:127], v[140:143]
    v_mul_u32_u24 v9, 1032, v3
    v_lshl_add_u32 v9, v4, 7, v9
    v_lshl_add_u32 v9, s3, 3, v9
    s_nop 2
    v_cvt_pk_bf16_f32 v176, v128, -v132
    v_cvt_pk_bf16_f32 v177, v129, -v133
    v_cvt_pk_bf16_f32 v178, v130, -v134
    v_cvt_pk_bf16_f32 v179, v131, -v135
    buffer_store_dwordx4 v[176:179], v13, s[12:15], s64 offen sc1
    v_cvt_pk_bf16_f32 v180, v136, -v140
    v_cvt_pk_bf16_f32 v181, v137, -v141
    v_cvt_pk_bf16_f32 v182, v138, -v142
    v_cvt_pk_bf16_f32 v183, v139, -v143
    buffer_store_dwordx4 v[180:183], v13, s[12:15], s65 offen sc1
    ds_read_b64 v[64:65], v9 offset:0
    ds_read_b64 v[66:67], v9 offset:32
    ds_read_b64 v[68:69], v9 offset:64
    ds_read_b64 v[70:71], v9 offset:96
    ds_read_b64 v[72:73], v9 offset:256
    ds_read_b64 v[74:75], v9 offset:288
    ds_read_b64 v[76:77], v9 offset:320
    ds_read_b64 v[78:79], v9 offset:352
    ds_read_b64 v[80:81], v9 offset:512
    ds_read_b64 v[82:83], v9 offset:544
    ds_read_b64 v[84:85], v9 offset:576
    ds_read_b64 v[86:87], v9 offset:608
    ds_read_b64 v[88:89], v9 offset:768
    ds_read_b64 v[90:91], v9 offset:800
    ds_read_b64 v[92:93], v9 offset:832
    ds_read_b64 v[94:95], v9 offset:864
    s_mov_b64 s[4:5], s[100:101]
    v_and_b32 v13, 3, v0
    v_mul_u32_u24 v13, 528, v13
    v_and_b32 v8, 60, v0
    v_add3_u32 v13, v13, v8, s40
    s_waitcnt vmcnt(6)
    v_pk_add_f32 v[192:193], v[192:193], v[196:197]
    v_pk_add_f32 v[194:195], v[194:195], v[198:199]
    v_pk_add_f32 v[200:201], v[200:201], v[204:205]
    v_pk_add_f32 v[202:203], v[202:203], v[206:207]
    v_pk_add_f32 v[192:193], v[192:193], v[200:201]
    v_pk_add_f32 v[194:195], v[194:195], v[202:203]
    v_cvt_pk_bf16_f32 v196, v192, v193
    v_cvt_pk_bf16_f32 v197, v194, v195
    v_lshlrev_b32 v192, 16, v196
    v_and_b32 v193, 0xffff0000, v196
    v_lshlrev_b32 v194, 16, v197
    v_and_b32 v195, 0xffff0000, v197
    v_add_f32 v192, s41, v192
    v_add_f32 v193, s41, v193
    v_add_f32 v194, s41, v194
    v_add_f32 v195, s41, v195
    v_cvt_pk_bf16_f32 v196, v192, v193
    v_cvt_pk_bf16_f32 v197, v194, v195
    v_lshlrev_b32 v192, 16, v196
    buffer_load_dwordx4 a[124:127], v2, s[32:35], s58 offen offset:3072 sc1
    s_add_u32 s58, s58, 102400
    v_and_b32 v193, 0xffff0000, v196
    v_lshlrev_b32 v194, 16, v197
    v_and_b32 v195, 0xffff0000, v197
    v_mul_f32 v192, s42, v192
    v_mul_f32 v193, s42, v193
    v_mul_f32 v194, s42, v194
    v_mul_f32 v195, s42, v195
    ds_write_b32 v13, v192 offset:0
    ds_write_b32 v13, v193 offset:128
    ds_write_b32 v13, v194 offset:256
    ds_write_b32 v13, v195 offset:384
    v_pk_add_f32 v[160:161], v[160:161], v[164:165]
    v_pk_add_f32 v[162:163], v[162:163], v[166:167]
    v_pk_add_f32 v[168:169], v[168:169], v[172:173]
    v_pk_add_f32 v[170:171], v[170:171], v[174:175]
    v_pk_add_f32 v[160:161], v[160:161], v[168:169]
    v_pk_add_f32 v[162:163], v[162:163], v[170:171]
    v_cvt_pk_bf16_f32 v164, v160, v161
    v_cvt_pk_bf16_f32 v165, v162, v163
    v_lshlrev_b32 v160, 16, v164
    v_and_b32 v161, 0xffff0000, v164
    v_lshlrev_b32 v162, 16, v165
    buffer_load_dwordx4 a[128:131], v2, s[32:35], s58 offen offset:0 sc1
    v_and_b32 v163, 0xffff0000, v165
    v_add_f32 v160, s41, v160
    v_add_f32 v161, s41, v161
    v_add_f32 v162, s41, v162
    v_add_f32 v163, s41, v163
    v_cvt_pk_bf16_f32 v164, v160, v161
    v_cvt_pk_bf16_f32 v165, v162, v163
    v_lshlrev_b32 v160, 16, v164
    v_and_b32 v161, 0xffff0000, v164
    v_lshlrev_b32 v162, 16, v165
    v_and_b32 v163, 0xffff0000, v165
    v_mul_f32 v160, s42, v160
    v_mul_f32 v161, s42, v161
    v_mul_f32 v162, s42, v162
    v_mul_f32 v163, s42, v163
    ds_write_b32 v13, v160 offset:64
    ds_write_b32 v13, v161 offset:192
    ds_write_b32 v13, v162 offset:320
    ds_write_b32 v13, v163 offset:448
    s_waitcnt lgkmcnt(15)
    v_lshlrev_b32 v128, 16, v64
    v_and_b32 v144, 0xffff0000, v64
    v_lshlrev_b32 v160, 16, v65
    v_and_b32 v176, 0xffff0000, v65
    buffer_load_dwordx4 a[132:135], v2, s[32:35], s58 offen offset:1024 sc1
    v_lshlrev_b32 v129, 16, v66
    v_and_b32 v145, 0xffff0000, v66
    v_lshlrev_b32 v161, 16, v67
    v_and_b32 v177, 0xffff0000, v67
    v_lshlrev_b32 v130, 16, v68
    v_and_b32 v146, 0xffff0000, v68
    v_lshlrev_b32 v162, 16, v69
    v_and_b32 v178, 0xffff0000, v69
    v_lshlrev_b32 v131, 16, v70
    v_and_b32 v147, 0xffff0000, v70
    v_lshlrev_b32 v163, 16, v71
    v_and_b32 v179, 0xffff0000, v71
    v_lshlrev_b32 v132, 16, v72
    v_and_b32 v148, 0xffff0000, v72
    v_lshlrev_b32 v164, 16, v73
    v_and_b32 v180, 0xffff0000, v73
    v_lshlrev_b32 v133, 16, v74
    v_and_b32 v149, 0xffff0000, v74
    v_lshlrev_b32 v165, 16, v75
    v_and_b32 v181, 0xffff0000, v75
    v_lshlrev_b32 v134, 16, v76
    v_and_b32 v150, 0xffff0000, v76
    buffer_load_dwordx4 a[136:139], v2, s[32:35], s58 offen offset:2048 sc1
    v_lshlrev_b32 v166, 16, v77
    v_and_b32 v182, 0xffff0000, v77
    v_lshlrev_b32 v135, 16, v78
    v_and_b32 v151, 0xffff0000, v78
    v_lshlrev_b32 v167, 16, v79
    v_and_b32 v183, 0xffff0000, v79
    v_lshlrev_b32 v136, 16, v80
    v_and_b32 v152, 0xffff0000, v80
    v_lshlrev_b32 v168, 16, v81
    v_and_b32 v184, 0xffff0000, v81
    s_waitcnt lgkmcnt(14)
    v_lshlrev_b32 v137, 16, v82
    v_and_b32 v153, 0xffff0000, v82
    v_lshlrev_b32 v169, 16, v83
    v_and_b32 v185, 0xffff0000, v83
    s_waitcnt lgkmcnt(13)
    v_lshlrev_b32 v138, 16, v84
    v_and_b32 v154, 0xffff0000, v84
    v_lshlrev_b32 v170, 16, v85
    v_and_b32 v186, 0xffff0000, v85
    s_waitcnt lgkmcnt(12)
    v_lshlrev_b32 v139, 16, v86
    v_and_b32 v155, 0xffff0000, v86
    v_lshlrev_b32 v171, 16, v87
    v_and_b32 v187, 0xffff0000, v87
    s_waitcnt lgkmcnt(11)
    v_lshlrev_b32 v140, 16, v88
    buffer_load_dwordx4 a[140:143], v2, s[32:35], s58 offen offset:3072 sc1
    s_add_u32 s58, s58, 4096
    v_and_b32 v156, 0xffff0000, v88
    v_lshlrev_b32 v172, 16, v89
    v_and_b32 v188, 0xffff0000, v89
    s_waitcnt lgkmcnt(10)
    v_lshlrev_b32 v141, 16, v90
    v_and_b32 v157, 0xffff0000, v90
    v_lshlrev_b32 v173, 16, v91
    v_and_b32 v189, 0xffff0000, v91
    s_waitcnt lgkmcnt(9)
    v_lshlrev_b32 v142, 16, v92
    v_and_b32 v158, 0xffff0000, v92
    v_lshlrev_b32 v174, 16, v93
    v_and_b32 v190, 0xffff0000, v93
    s_waitcnt lgkmcnt(8)
    v_lshlrev_b32 v143, 16, v94
    v_and_b32 v159, 0xffff0000, v94
    v_lshlrev_b32 v175, 16, v95
    v_and_b32 v191, 0xffff0000, v95
    v_lshl_add_u32 v7, v3, 2, s79
    s_cmp_eq_u32 s3, 0
    s_cselect_b32 s25, 0, 2048
    v_add_u32 v10, 4096, v2
    v_add_u32 v11, s25, v10
    v_and_b32 v12, 7, v3
    v_lshrrev_b32 v13, 3, v3
    v_lshl_add_u32 v12, v12, 2, v13
    v_lshlrev_b32 v1, 1, v12
    v_mov_b32 v8, 8192
    v_mov_b32 v9, s94
    s_waitcnt vmcnt(5) lgkmcnt(0)
    s_barrier
    s_mov_b64 exec, 1
    buffer_store_dword v9, v8, s[12:15], s61 offen sc1
    s_mov_b64 exec, -1
    ds_read_b32 v12, v7 offset:4224
    ds_read_b32 v13, v7 offset:4352
    ds_read_b32 v14, v7 offset:4480
    ds_read_b32 v15, v7 offset:4608
    global_load_dwordx4 v[48:51], v11, s[16:17]
    global_load_dwordx4 v[52:55], v11, s[16:17] offset:1024
    global_load_dwordx4 v[56:59], v10, s[16:17] offset:2048
    global_load_dwordx4 v[60:63], v10, s[16:17] offset:3072
    buffer_load_ushort v208, v1, s[8:11], s45 offen
    buffer_load_ushort v209, v1, s[8:11], s46 offen
    buffer_load_ushort v210, v1, s[8:11], s47 offen
    s_mov_b32 s26, -1
    s_mov_b32 s27, 0
    s_mov_b32 s6, 0x200000
    v_and_b32 v11, 1, v3
    v_cvt_f32_u32 v11, v11
    v_fma_f32 v11, v11, -2.0, 1.0
    v_lshlrev_b32 v8, 2, v4
    v_cvt_f32_u32 v8, v8
    v_lshlrev_b32 v7, 4, v3
    v_lshl_add_u32 v7, s3, 2, v7
    v_cvt_f32_u32 v7, v7
    v_add_f32 v9, 0x00000000, v7
    v_mul_f32 v10, 0x3b000000, v9
    v_mul_f32 v9, v8, v10
    v_cos_f32 v200, v10
    buffer_load_dwordx4 a[144:147], v2, s[32:35], s58 offen offset:0 sc1
    v_sin_f32 v201, v10
    v_cos_f32 v192, v9
    v_sin_f32 v193, v9
    s_waitcnt lgkmcnt(2)
    v_pk_mul_f32 v[192:193], v[192:193], v[12:13] op_sel:[0,0] op_sel_hi:[1,0]
    v_pk_mul_f32 v[194:195], v[192:193], v[200:201] op_sel_hi:[1,0]
    v_pk_fma_f32 v[194:195], v[192:193], v[200:201], v[194:195] op_sel:[1,1,0] op_sel_hi:[0,1,1] neg_lo:[1,0,0]
    v_pk_mul_f32 v[196:197], v[194:195], v[200:201] op_sel_hi:[1,0]
    v_pk_fma_f32 v[196:197], v[194:195], v[200:201], v[196:197] op_sel:[1,1,0] op_sel_hi:[0,1,1] neg_lo:[1,0,0]
    v_pk_mul_f32 v[198:199], v[196:197], v[200:201] op_sel_hi:[1,0]
    buffer_load_dwordx4 a[148:151], v2, s[32:35], s58 offen offset:1024 sc1
    v_pk_fma_f32 v[198:199], v[196:197], v[200:201], v[198:199] op_sel:[1,1,0] op_sel_hi:[0,1,1] neg_lo:[1,0,0]
    v_mul_f32 v203, v11, v12
    v_cndmask_b32 v193, v193, -v203, s[26:27]
    v_cvt_pk_bf16_f32 v96, v192, -v193
    v_cvt_pk_bf16_f32 v97, v194, -v195
    v_cvt_pk_bf16_f32 v98, v196, -v197
    v_cvt_pk_bf16_f32 v99, v198, -v199
    v_fmamk_f32 v202, v10, 0x41000000, v9
    v_cos_f32 v192, v202
    v_sin_f32 v193, v202
    s_nop 0
    v_pk_mul_f32 v[192:193], v[192:193], v[12:13] op_sel:[0,0] op_sel_hi:[1,0]
    buffer_load_dwordx4 a[152:155], v2, s[32:35], s58 offen offset:2048 sc1
    v_pk_mul_f32 v[194:195], v[192:193], v[200:201] op_sel_hi:[1,0]
    v_pk_fma_f32 v[194:195], v[192:193], v[200:201], v[194:195] op_sel:[1,1,0] op_sel_hi:[0,1,1] neg_lo:[1,0,0]
    v_pk_mul_f32 v[196:197], v[194:195], v[200:201] op_sel_hi:[1,0]
    v_pk_fma_f32 v[196:197], v[194:195], v[200:201], v[196:197] op_sel:[1,1,0] op_sel_hi:[0,1,1] neg_lo:[1,0,0]
    v_pk_mul_f32 v[198:199], v[196:197], v[200:201] op_sel_hi:[1,0]
    v_pk_fma_f32 v[198:199], v[196:197], v[200:201], v[198:199] op_sel:[1,1,0] op_sel_hi:[0,1,1] neg_lo:[1,0,0]
    v_cvt_pk_bf16_f32 v100, v192, -v193
    v_cvt_pk_bf16_f32 v101, v194, -v195
    v_cvt_pk_bf16_f32 v102, v196, -v197
    v_cvt_pk_bf16_f32 v103, v198, -v199
    v_add_f32 v9, 0x3f800000, v7
    v_mul_f32 v10, 0x3b000000, v9
    buffer_load_dwordx4 a[156:159], v2, s[32:35], s58 offen offset:3072 sc1
    s_add_u32 s58, s58, 4096
    v_mul_f32 v9, v8, v10
    v_cos_f32 v200, v10
    v_sin_f32 v201, v10
    v_cos_f32 v192, v9
    v_sin_f32 v193, v9
    s_nop 0
    v_pk_mul_f32 v[192:193], v[192:193], v[12:13] op_sel:[0,1] op_sel_hi:[1,1]
    v_pk_mul_f32 v[194:195], v[192:193], v[200:201] op_sel_hi:[1,0]
    v_pk_fma_f32 v[194:195], v[192:193], v[200:201], v[194:195] op_sel:[1,1,0] op_sel_hi:[0,1,1] neg_lo:[1,0,0]
    v_pk_mul_f32 v[196:197], v[194:195], v[200:201] op_sel_hi:[1,0]
    buffer_load_dwordx4 a[160:163], v2, s[32:35], s58 offen offset:0 sc1
    v_pk_fma_f32 v[196:197], v[194:195], v[200:201], v[196:197] op_sel:[1,1,0] op_sel_hi:[0,1,1] neg_lo:[1,0,0]
    v_pk_mul_f32 v[198:199], v[196:197], v[200:201] op_sel_hi:[1,0]
    v_pk_fma_f32 v[198:199], v[196:197], v[200:201], v[198:199] op_sel:[1,1,0] op_sel_hi:[0,1,1] neg_lo:[1,0,0]
    v_mul_f32 v203, v11, v13
    v_cndmask_b32 v193, v193, -v203, s[26:27]
    v_cvt_pk_bf16_f32 v104, v192, -v193
    v_cvt_pk_bf16_f32 v105, v194, -v195
    v_cvt_pk_bf16_f32 v106, v196, -v197
    v_cvt_pk_bf16_f32 v107, v198, -v199
    v_fmamk_f32 v202, v10, 0x41000000, v9
    v_cos_f32 v192, v202
    buffer_load_dwordx4 a[164:167], v2, s[32:35], s58 offen offset:1024 sc1
    v_sin_f32 v193, v202
    s_nop 0
    v_pk_mul_f32 v[192:193], v[192:193], v[12:13] op_sel:[0,1] op_sel_hi:[1,1]
    v_pk_mul_f32 v[194:195], v[192:193], v[200:201] op_sel_hi:[1,0]
    v_pk_fma_f32 v[194:195], v[192:193], v[200:201], v[194:195] op_sel:[1,1,0] op_sel_hi:[0,1,1] neg_lo:[1,0,0]
    v_pk_mul_f32 v[196:197], v[194:195], v[200:201] op_sel_hi:[1,0]
    v_pk_fma_f32 v[196:197], v[194:195], v[200:201], v[196:197] op_sel:[1,1,0] op_sel_hi:[0,1,1] neg_lo:[1,0,0]
    v_pk_mul_f32 v[198:199], v[196:197], v[200:201] op_sel_hi:[1,0]
    v_pk_fma_f32 v[198:199], v[196:197], v[200:201], v[198:199] op_sel:[1,1,0] op_sel_hi:[0,1,1] neg_lo:[1,0,0]
    v_cvt_pk_bf16_f32 v108, v192, -v193
    v_cvt_pk_bf16_f32 v109, v194, -v195
    v_cvt_pk_bf16_f32 v110, v196, -v197
    v_cvt_pk_bf16_f32 v111, v198, -v199
    buffer_load_dwordx4 a[168:171], v2, s[32:35], s58 offen offset:2048 sc1
    v_add_f32 v9, 0x40000000, v7
    v_mul_f32 v10, 0x3b000000, v9
    v_mul_f32 v9, v8, v10
    v_cos_f32 v200, v10
    v_sin_f32 v201, v10
    v_cos_f32 v192, v9
    v_sin_f32 v193, v9
    s_waitcnt lgkmcnt(0)
    v_pk_mul_f32 v[192:193], v[192:193], v[14:15] op_sel:[0,0] op_sel_hi:[1,0]
    buffer_load_dwordx4 a[172:175], v2, s[32:35], s58 offen offset:3072 sc1
    s_add_u32 s58, s58, 4096
    v_pk_mul_f32 v[194:195], v[192:193], v[200:201] op_sel_hi:[1,0]
    v_pk_fma_f32 v[194:195], v[192:193], v[200:201], v[194:195] op_sel:[1,1,0] op_sel_hi:[0,1,1] neg_lo:[1,0,0]
    v_pk_mul_f32 v[196:197], v[194:195], v[200:201] op_sel_hi:[1,0]
    v_pk_fma_f32 v[196:197], v[194:195], v[200:201], v[196:197] op_sel:[1,1,0] op_sel_hi:[0,1,1] neg_lo:[1,0,0]
    v_pk_mul_f32 v[198:199], v[196:197], v[200:201] op_sel_hi:[1,0]
    v_pk_fma_f32 v[198:199], v[196:197], v[200:201], v[198:199] op_sel:[1,1,0] op_sel_hi:[0,1,1] neg_lo:[1,0,0]
    v_mul_f32 v203, v11, v14
    v_cndmask_b32 v193, v193, -v203, s[26:27]
    v_cvt_pk_bf16_f32 v112, v192, -v193
    v_cvt_pk_bf16_f32 v113, v194, -v195
    v_cvt_pk_bf16_f32 v114, v196, -v197
    v_cvt_pk_bf16_f32 v115, v198, -v199
    v_fmamk_f32 v202, v10, 0x41000000, v9
    buffer_load_dwordx4 a[176:179], v2, s[32:35], s58 offen offset:0 sc1
    v_cos_f32 v192, v202
    v_sin_f32 v193, v202
    s_nop 0
    v_pk_mul_f32 v[192:193], v[192:193], v[14:15] op_sel:[0,0] op_sel_hi:[1,0]
    v_pk_mul_f32 v[194:195], v[192:193], v[200:201] op_sel_hi:[1,0]
    v_pk_fma_f32 v[194:195], v[192:193], v[200:201], v[194:195] op_sel:[1,1,0] op_sel_hi:[0,1,1] neg_lo:[1,0,0]
    v_pk_mul_f32 v[196:197], v[194:195], v[200:201] op_sel_hi:[1,0]
    v_pk_fma_f32 v[196:197], v[194:195], v[200:201], v[196:197] op_sel:[1,1,0] op_sel_hi:[0,1,1] neg_lo:[1,0,0]
    v_pk_mul_f32 v[198:199], v[196:197], v[200:201] op_sel_hi:[1,0]
    v_pk_fma_f32 v[198:199], v[196:197], v[200:201], v[198:199] op_sel:[1,1,0] op_sel_hi:[0,1,1] neg_lo:[1,0,0]
    v_cvt_pk_bf16_f32 v116, v192, -v193
    buffer_load_dwordx4 a[180:183], v2, s[32:35], s58 offen offset:1024 sc1
    v_cvt_pk_bf16_f32 v117, v194, -v195
    v_cvt_pk_bf16_f32 v118, v196, -v197
    v_cvt_pk_bf16_f32 v119, v198, -v199
    v_add_f32 v9, 0x40400000, v7
    v_mul_f32 v10, 0x3b000000, v9
    v_mul_f32 v9, v8, v10
    v_cos_f32 v200, v10
    v_sin_f32 v201, v10
    v_cos_f32 v192, v9
    v_sin_f32 v193, v9
    buffer_load_dwordx4 a[184:187], v2, s[32:35], s58 offen offset:2048 sc1
    v_pk_mul_f32 v[192:193], v[192:193], v[14:15] op_sel:[0,1] op_sel_hi:[1,1]
    v_pk_mul_f32 v[194:195], v[192:193], v[200:201] op_sel_hi:[1,0]
    v_pk_fma_f32 v[194:195], v[192:193], v[200:201], v[194:195] op_sel:[1,1,0] op_sel_hi:[0,1,1] neg_lo:[1,0,0]
    v_pk_mul_f32 v[196:197], v[194:195], v[200:201] op_sel_hi:[1,0]
    v_pk_fma_f32 v[196:197], v[194:195], v[200:201], v[196:197] op_sel:[1,1,0] op_sel_hi:[0,1,1] neg_lo:[1,0,0]
    v_pk_mul_f32 v[198:199], v[196:197], v[200:201] op_sel_hi:[1,0]
    v_pk_fma_f32 v[198:199], v[196:197], v[200:201], v[198:199] op_sel:[1,1,0] op_sel_hi:[0,1,1] neg_lo:[1,0,0]
    v_mul_f32 v203, v11, v15
    v_cndmask_b32 v193, v193, -v203, s[26:27]
    v_cvt_pk_bf16_f32 v120, v192, -v193
    v_cvt_pk_bf16_f32 v121, v194, -v195
    buffer_load_dwordx4 a[188:191], v2, s[32:35], s58 offen offset:3072 sc1
    s_add_u32 s58, s58, 4096
    v_cvt_pk_bf16_f32 v122, v196, -v197
    v_cvt_pk_bf16_f32 v123, v198, -v199
    v_fmamk_f32 v202, v10, 0x41000000, v9
    v_cos_f32 v192, v202
    v_sin_f32 v193, v202
    s_nop 0
    v_pk_mul_f32 v[192:193], v[192:193], v[14:15] op_sel:[0,1] op_sel_hi:[1,1]
    v_pk_mul_f32 v[194:195], v[192:193], v[200:201] op_sel_hi:[1,0]
    v_pk_fma_f32 v[194:195], v[192:193], v[200:201], v[194:195] op_sel:[1,1,0] op_sel_hi:[0,1,1] neg_lo:[1,0,0]
    v_pk_mul_f32 v[196:197], v[194:195], v[200:201] op_sel_hi:[1,0]
    v_pk_fma_f32 v[196:197], v[194:195], v[200:201], v[196:197] op_sel:[1,1,0] op_sel_hi:[0,1,1] neg_lo:[1,0,0]
    v_pk_mul_f32 v[198:199], v[196:197], v[200:201] op_sel_hi:[1,0]
    buffer_load_dwordx4 a[192:195], v2, s[32:35], s58 offen offset:0 sc1
    v_pk_fma_f32 v[198:199], v[196:197], v[200:201], v[198:199] op_sel:[1,1,0] op_sel_hi:[0,1,1] neg_lo:[1,0,0]
    v_cvt_pk_bf16_f32 v124, v192, -v193
    v_cvt_pk_bf16_f32 v125, v194, -v195
    v_cvt_pk_bf16_f32 v126, v196, -v197
    v_cvt_pk_bf16_f32 v127, v198, -v199
    v_lshlrev_b32 v7, 12, v6
    v_lshl_add_u32 v7, v5, 4, v7
    v_lshlrev_b32 v11, 7, v0
    s_add_u32 s29, s43, 16384
    buffer_load_dwordx4 a[196:199], v2, s[32:35], s58 offen offset:1024 sc1
    buffer_load_dwordx4 a[200:203], v2, s[32:35], s58 offen offset:2048 sc1
    buffer_load_dwordx4 a[204:207], v2, s[32:35], s58 offen offset:3072 sc1
    s_add_u32 s58, s58, 4096
    v_lshlrev_b32 v1, 1, v2
    s_cmp_eq_u32 s3, 3
    s_cselect_b32 s0, 0, 2147483392
    s_add_u32 s0, s0, 270336
    s_add_u32 s95, s0, 4096
    buffer_load_dword v204, v1, s[12:15], s0 offen offset:0 sc1
    buffer_load_dword v205, v1, s[12:15], s0 offen offset:2048 sc1
    buffer_load_dword v206, v1, s[12:15], s95 offen offset:0 sc1
    buffer_load_dword v207, v1, s[12:15], s95 offen offset:2048 sc1
    buffer_load_dwordx4 a[208:211], v2, s[32:35], s58 offen offset:0 sc1
    buffer_load_dwordx4 a[212:215], v2, s[32:35], s58 offen offset:1024 sc1
    buffer_load_dwordx4 a[216:219], v2, s[32:35], s58 offen offset:2048 sc1
    buffer_load_dwordx4 a[220:223], v2, s[32:35], s58 offen offset:3072 sc1
    s_add_u32 s58, s58, 4096
    buffer_load_dwordx4 a[224:227], v2, s[32:35], s58 offen offset:0 sc1
    buffer_load_dwordx4 a[228:231], v2, s[32:35], s58 offen offset:1024 sc1
    buffer_load_dwordx4 a[232:235], v2, s[32:35], s58 offen offset:2048 sc1
    buffer_load_dwordx4 a[236:239], v2, s[32:35], s58 offen offset:3072 sc1
    s_add_u32 s58, s58, 4096
    buffer_load_dwordx4 a[240:243], v2, s[32:35], s58 offen offset:0 sc1
    buffer_load_dwordx4 a[244:247], v2, s[32:35], s58 offen offset:1024 sc1
    s_cmp_lg_u32 s3, 3
    s_cbranch_scc1 L_bur_h2
    s_waitcnt vmcnt(13)
    v_xor_b32 v9, s94, v204
    s_waitcnt vmcnt(12)
    v_bitop3_b32 v9, v205, s94, v9 bitop3:0xbe
    s_waitcnt vmcnt(11)
    v_bitop3_b32 v9, v206, s94, v9 bitop3:0xbe
    s_waitcnt vmcnt(10)
    v_bitop3_b32 v9, v207, s94, v9 bitop3:0xbe
    v_cmp_ne_u32 vcc, 0, v9
    s_nop 1
    s_cbranch_vccz L_rel_h2
    s_mov_b32 s30, 0
L_poll_h2:
    s_mov_b64 exec, vcc
    buffer_load_dword v204, v1, s[12:15], s0 offen offset:0 sc1
    buffer_load_dword v205, v1, s[12:15], s0 offen offset:2048 sc1
    buffer_load_dword v206, v1, s[12:15], s95 offen offset:0 sc1
    buffer_load_dword v207, v1, s[12:15], s95 offen offset:2048 sc1
    s_waitcnt vmcnt(3)
    v_xor_b32 v9, s94, v204
    s_waitcnt vmcnt(2)
    v_bitop3_b32 v9, v205, s94, v9 bitop3:0xbe
    s_waitcnt vmcnt(1)
    v_bitop3_b32 v9, v206, s94, v9 bitop3:0xbe
    s_waitcnt vmcnt(0)
    v_bitop3_b32 v9, v207, s94, v9 bitop3:0xbe
    v_cmp_ne_u32 vcc, 0, v9
    s_add_u32 s30, s30, 1
    s_cmp_ge_u32 s30, 20000
    s_cbranch_scc1 L_pd_h2
    s_cmp_eq_u64 vcc, 0
    s_cbranch_scc1 L_pd_h2
    s_sleep 6
    s_branch L_poll_h2
L_pd_h2:
    s_mov_b64 exec, -1
    s_branch L_rel_h2
L_bur_h2:
    s_mov_b32 m0, s60
    s_nop 0
    buffer_load_dwordx4 v2, s[32:35], s59 offen offset:2048 sc1 lds
    s_mov_b32 m0, s60
    s_nop 0
    buffer_load_dwordx4 v2, s[32:35], s59 offen offset:3072 sc1 lds
    s_add_u32 s59, s59, s31
    s_add_u32 s60, s60, s31
    s_mov_b32 m0, s60
    s_nop 0
    buffer_load_dwordx4 v2, s[32:35], s59 offen offset:0 sc1 lds
    s_mov_b32 m0, s60
    s_nop 0
    buffer_load_dwordx4 v2, s[32:35], s59 offen offset:1024 sc1 lds
    s_mov_b32 m0, s60
    s_nop 0
    buffer_load_dwordx4 v2, s[32:35], s59 offen offset:2048 sc1 lds
    s_mov_b32 m0, s60
    s_nop 0
    buffer_load_dwordx4 v2, s[32:35], s59 offen offset:3072 sc1 lds
    s_add_u32 s59, s59, s31
    s_add_u32 s60, s60, s31
    s_mov_b32 m0, s60
    s_nop 0
    buffer_load_dwordx4 v2, s[32:35], s59 offen offset:0 sc1 lds
    s_mov_b32 m0, s60
    s_nop 0
    buffer_load_dwordx4 v2, s[32:35], s59 offen offset:1024 sc1 lds
    s_mov_b32 m0, s60
    s_nop 0
    buffer_load_dwordx4 v2, s[32:35], s59 offen offset:2048 sc1 lds
    s_mov_b32 m0, s60
    s_nop 0
    buffer_load_dwordx4 v2, s[32:35], s59 offen offset:3072 sc1 lds
    s_add_u32 s59, s59, s31
    s_add_u32 s60, s60, s31
L_rel_h2:
    s_barrier
    buffer_load_dwordx4 v[16:19], v7, s[12:15], s43 offen offset:0 sc1
    buffer_load_dwordx4 v[20:23], v7, s[12:15], s29 offen offset:0 sc1
    buffer_load_dwordx4 v[24:27], v7, s[12:15], s43 offen offset:256 sc1
    buffer_load_dwordx4 v[28:31], v7, s[12:15], s29 offen offset:256 sc1
    buffer_load_dwordx4 v[32:35], v7, s[12:15], s43 offen offset:512 sc1
    buffer_load_dwordx4 v[36:39], v7, s[12:15], s29 offen offset:512 sc1
    buffer_load_dwordx4 v[40:43], v7, s[12:15], s43 offen offset:768 sc1
    buffer_load_dwordx4 v[44:47], v7, s[12:15], s29 offen offset:768 sc1
    s_add_u32 s24, s51, 0
    s_add_u32 s25, s51, 8192
    s_add_u32 s26, s51, 16384
    v_mov_b32 v14, v11
    v_lshl_add_u32 v13, s3, 9, v7
    v_lshlrev_b32 v10, 9, v4
    v_lshl_add_u32 v10, v3, 4, v10
    v_lshl_add_u32 v10, s3, 13, v10
    v_lshl_add_u32 v12, v4, 4, s79
    v_mul_u32_u24 v7, 80, v3
    v_lshl_add_u32 v11, v4, 3, v7
    v_lshl_add_u32 v11, s3, 4, v11
    v_lshlrev_b32 v9, 13, v4
    v_lshl_add_u32 v9, v3, 4, v9
    v_lshl_add_u32 v9, s3, 10, v9
    v_lshl_add_u32 v8, s3, 13, v2
    s_lshl_b32 s28, s20, 2
    s_mov_b32 s22, -1
    s_mov_b32 s23, 0
    s_waitcnt vmcnt(40)
    v_lshlrev_b32 v208, 16, v208
    v_mul_f32 v208, 0x3fb8aa3b, v208
    v_cvt_pk_bf16_f32 v212, v208, v208
    v_and_b32 v212, 0xffff0000, v212
    v_sub_f32 v213, v208, v212
    v_cvt_pk_bf16_f32 v212, v212, v213
    v_cndmask_b32 v5, 0, v212, s[22:23]
    s_waitcnt vmcnt(39)
    v_lshlrev_b32 v209, 16, v209
    v_mul_f32 v209, 0x3fb8aa3b, v209
    v_cvt_pk_bf16_f32 v212, v209, v209
    v_and_b32 v212, 0xffff0000, v212
    v_sub_f32 v213, v209, v212
    v_cvt_pk_bf16_f32 v212, v212, v213
    v_cndmask_b32 v6, 0, v212, s[22:23]
    s_waitcnt vmcnt(38)
    v_lshlrev_b32 v210, 16, v210
    v_mul_f32 v210, 0x3fb8aa3b, v210
    v_cvt_pk_bf16_f32 v212, v210, v210
    v_and_b32 v212, 0xffff0000, v212
    v_sub_f32 v213, v210, v212
    v_cvt_pk_bf16_f32 v212, v212, v213
    v_cndmask_b32 v0, 0, v212, s[22:23]
    s_mov_b32 m0, s60
    s_nop 0
    buffer_load_dwordx4 v2, s[32:35], s59 offen offset:0 sc1 lds
    s_mov_b32 m0, s60
    s_nop 0
    buffer_load_dwordx4 v2, s[32:35], s59 offen offset:1024 sc1 lds
    s_mov_b32 m0, s60
    s_nop 0
    buffer_load_dwordx4 v2, s[32:35], s59 offen offset:2048 sc1 lds
    s_mov_b32 m0, s60
    s_nop 0
    buffer_load_dwordx4 v2, s[32:35], s59 offen offset:3072 sc1 lds
    s_add_u32 s59, s59, s31
    s_add_u32 s60, s60, s31
    s_mov_b32 m0, s60
    s_nop 0
    buffer_load_dwordx4 v2, s[32:35], s59 offen offset:0 sc1 lds
    s_mov_b32 m0, s60
    s_nop 0
    buffer_load_dwordx4 v2, s[32:35], s59 offen offset:1024 sc1 lds
    s_waitcnt vmcnt(13)
    v_mfma_f32_16x16x32_bf16 v[192:195], v[16:19], v[224:227], 0
    v_mfma_f32_16x16x32_bf16 v[196:199], v[16:19], v[240:243], 0
    v_mfma_f32_16x16x32_bf16 v[200:203], v[16:19], v[232:235], 0
    v_mfma_f32_16x16x32_bf16 v[204:207], v[16:19], v[248:251], 0
    s_waitcnt vmcnt(12)
    v_mfma_f32_16x16x32_bf16 v[192:195], v[20:23], v[228:231], v[192:195]
    v_mfma_f32_16x16x32_bf16 v[196:199], v[20:23], v[244:247], v[196:199]
    v_mfma_f32_16x16x32_bf16 v[200:203], v[20:23], v[236:239], v[200:203]
    v_mfma_f32_16x16x32_bf16 v[204:207], v[20:23], v[252:255], v[204:207]
    s_waitcnt vmcnt(11)
    v_mfma_f32_16x16x32_bf16 v[208:211], v[24:27], v[224:227], 0
    v_mfma_f32_16x16x32_bf16 v[212:215], v[24:27], v[240:243], 0
    v_mfma_f32_16x16x32_bf16 v[216:219], v[24:27], v[232:235], 0
    v_mfma_f32_16x16x32_bf16 v[220:223], v[24:27], v[248:251], 0
    s_nop 0
    v_cvt_pk_bf16_f32 v16, v192, v196
    v_cvt_pk_bf16_f32 v17, v193, v197
    s_waitcnt vmcnt(10)
    v_mfma_f32_16x16x32_bf16 v[208:211], v[28:31], v[228:231], v[208:211]
    v_cvt_pk_bf16_f32 v18, v194, v198
    s_mov_b32 m0, s60
    s_nop 0
    buffer_load_dwordx4 v2, s[32:35], s59 offen offset:2048 sc1 lds
    v_cvt_pk_bf16_f32 v19, v195, v199
    v_mfma_f32_16x16x32_bf16 v[212:215], v[28:31], v[244:247], v[212:215]
    v_cvt_pk_bf16_f32 v20, v200, v204
    v_cvt_pk_bf16_f32 v21, v201, v205
    v_mfma_f32_16x16x32_bf16 v[216:219], v[28:31], v[236:239], v[216:219]
    v_cvt_pk_bf16_f32 v22, v202, v206
    v_cvt_pk_bf16_f32 v23, v203, v207
    v_mfma_f32_16x16x32_bf16 v[220:223], v[28:31], v[252:255], v[220:223]
    v_mfma_f32_16x16x32_bf16 v[192:195], v[48:51], v[16:19], 0
    s_nop 0
    v_cvt_pk_bf16_f32 v24, v208, v212
    s_mov_b32 m0, s60
    s_nop 0
    buffer_load_dwordx4 v2, s[32:35], s59 offen offset:3072 sc1 lds
    s_add_u32 s59, s59, s31
    s_add_u32 s60, s60, s31
    v_cvt_pk_bf16_f32 v25, v209, v213
    v_mfma_f32_16x16x32_bf16 v[196:199], v[52:55], v[16:19], 0
    v_cvt_pk_bf16_f32 v26, v210, v214
    v_cvt_pk_bf16_f32 v27, v211, v215
    v_mfma_f32_16x16x32_bf16 v[200:203], v[48:51], v[20:23], 0
    v_cvt_pk_bf16_f32 v28, v216, v220
    v_cvt_pk_bf16_f32 v29, v217, v221
    v_mfma_f32_16x16x32_bf16 v[204:207], v[52:55], v[20:23], 0
    v_cvt_pk_bf16_f32 v30, v218, v222
    v_cvt_pk_bf16_f32 v31, v219, v223
    v_mfma_f32_16x16x32_bf16 v[208:211], v[56:59], v[24:27], 0
    buffer_load_dwordx4 a[248:251], v2, s[32:35], s58 offen offset:2048 sc1
    v_mfma_f32_16x16x32_bf16 v[212:215], v[60:63], v[24:27], 0
    v_cvt_pk_bf16_f32 v64, v192, v193
    v_cvt_pk_bf16_f32 v68, v194, v195
    v_cvt_pk_bf16_f32 v72, v196, v197
    v_mfma_f32_16x16x32_bf16 v[216:219], v[56:59], v[28:31], 0
    v_cvt_pk_bf16_f32 v76, v198, v199
    v_cvt_pk_bf16_f32 v80, v200, v201
    v_cvt_pk_bf16_f32 v84, v202, v203
    v_mfma_f32_16x16x32_bf16 v[220:223], v[60:63], v[28:31], 0
    v_cvt_pk_bf16_f32 v88, v204, v205
    v_cvt_pk_bf16_f32 v92, v206, v207
    s_waitcnt vmcnt(12)
    v_mfma_f32_16x16x32_bf16 v[192:195], v[32:35], v[224:227], 0
    buffer_load_dwordx4 a[252:255], v2, s[32:35], s58 offen offset:3072 sc1
    s_add_u32 s58, s58, 102400
    v_mfma_f32_16x16x32_bf16 v[196:199], v[32:35], v[240:243], 0
    v_cvt_pk_bf16_f32 v65, v208, v209
    v_cvt_pk_bf16_f32 v69, v210, v211
    v_mfma_f32_16x16x32_bf16 v[200:203], v[32:35], v[232:235], 0
    v_cvt_pk_bf16_f32 v73, v212, v213
    v_cvt_pk_bf16_f32 v77, v214, v215
    v_mfma_f32_16x16x32_bf16 v[204:207], v[32:35], v[248:251], 0
    v_cvt_pk_bf16_f32 v81, v216, v217
    v_cvt_pk_bf16_f32 v85, v218, v219
    s_waitcnt vmcnt(12)
    v_mfma_f32_16x16x32_bf16 v[192:195], v[36:39], v[228:231], v[192:195]
    v_cvt_pk_bf16_f32 v89, v220, v221
    v_cvt_pk_bf16_f32 v93, v222, v223
    v_mfma_f32_16x16x32_bf16 v[196:199], v[36:39], v[244:247], v[196:199]
    v_mfma_f32_16x16x32_bf16 v[200:203], v[36:39], v[236:239], v[200:203]
    v_mfma_f32_16x16x32_bf16 v[204:207], v[36:39], v[252:255], v[204:207]
    s_waitcnt vmcnt(11)
    v_mfma_f32_16x16x32_bf16 v[208:211], v[40:43], v[224:227], 0
    v_mfma_f32_16x16x32_bf16 v[212:215], v[40:43], v[240:243], 0
    v_mfma_f32_16x16x32_bf16 v[216:219], v[40:43], v[232:235], 0
    v_mfma_f32_16x16x32_bf16 v[220:223], v[40:43], v[248:251], 0
    s_nop 0
    v_cvt_pk_bf16_f32 v32, v192, v196
    v_cvt_pk_bf16_f32 v33, v193, v197
    s_waitcnt vmcnt(10)
    v_mfma_f32_16x16x32_bf16 v[208:211], v[44:47], v[228:231], v[208:211]
    v_cvt_pk_bf16_f32 v34, v194, v198
    v_cvt_pk_bf16_f32 v35, v195, v199
    v_mfma_f32_16x16x32_bf16 v[212:215], v[44:47], v[244:247], v[212:215]
    v_cvt_pk_bf16_f32 v36, v200, v204
    v_cvt_pk_bf16_f32 v37, v201, v205
    v_mfma_f32_16x16x32_bf16 v[216:219], v[44:47], v[236:239], v[216:219]
    v_cvt_pk_bf16_f32 v38, v202, v206
    v_cvt_pk_bf16_f32 v39, v203, v207
    v_mfma_f32_16x16x32_bf16 v[220:223], v[44:47], v[252:255], v[220:223]
    v_mfma_f32_16x16x32_bf16 v[192:195], v[56:59], v[32:35], 0
    s_nop 0
    v_cvt_pk_bf16_f32 v40, v208, v212
    v_cvt_pk_bf16_f32 v41, v209, v213
    v_mfma_f32_16x16x32_bf16 v[196:199], v[60:63], v[32:35], 0
    v_cvt_pk_bf16_f32 v42, v210, v214
    v_cvt_pk_bf16_f32 v43, v211, v215
    v_mfma_f32_16x16x32_bf16 v[200:203], v[56:59], v[36:39], 0
    v_cvt_pk_bf16_f32 v44, v216, v220
    v_cvt_pk_bf16_f32 v45, v217, v221
    v_mfma_f32_16x16x32_bf16 v[204:207], v[60:63], v[36:39], 0
    v_cvt_pk_bf16_f32 v46, v218, v222
    v_cvt_pk_bf16_f32 v47, v219, v223
    v_mfma_f32_16x16x32_bf16 v[208:211], v[56:59], v[40:43], 0
    v_mfma_f32_16x16x32_bf16 v[212:215], v[60:63], v[40:43], 0
    v_cvt_pk_bf16_f32 v66, v192, v193
    v_cvt_pk_bf16_f32 v70, v194, v195
    v_cvt_pk_bf16_f32 v74, v196, v197
    v_mfma_f32_16x16x32_bf16 v[216:219], v[56:59], v[44:47], 0
    v_cvt_pk_bf16_f32 v78, v198, v199
    v_cvt_pk_bf16_f32 v82, v200, v201
    v_cvt_pk_bf16_f32 v86, v202, v203
    v_mfma_f32_16x16x32_bf16 v[220:223], v[60:63], v[44:47], 0
    v_cvt_pk_bf16_f32 v90, v204, v205
    v_cvt_pk_bf16_f32 v94, v206, v207
    v_cvt_pk_bf16_f32 v67, v208, v209
    ds_write_b128 v13, v[64:67] offset:0
    v_cvt_pk_bf16_f32 v71, v210, v211
    ds_write_b128 v13, v[68:71] offset:2048
    v_cvt_pk_bf16_f32 v75, v212, v213
    ds_write_b128 v13, v[72:75] offset:16384
    v_cvt_pk_bf16_f32 v79, v214, v215
    ds_write_b128 v13, v[76:79] offset:18432
    v_cvt_pk_bf16_f32 v83, v216, v217
    ds_write_b128 v13, v[80:83] offset:256
    v_cvt_pk_bf16_f32 v87, v218, v219
    ds_write_b128 v13, v[84:87] offset:2304
    v_cvt_pk_bf16_f32 v91, v220, v221
    ds_write_b128 v13, v[88:91] offset:16640
    v_cvt_pk_bf16_f32 v95, v222, v223
    ds_write_b128 v13, v[92:95] offset:18688
    buffer_load_dwordx4 v[192:195], v2, s[36:39], s52 offen offset:0 sc1
    buffer_load_dwordx4 v[196:199], v2, s[36:39], s53 offen offset:0 sc1
    buffer_load_dwordx4 v[200:203], v2, s[36:39], s52 offen offset:1024 sc1
    buffer_load_dwordx4 v[204:207], v2, s[36:39], s53 offen offset:1024 sc1
    buffer_load_dwordx4 v[208:211], v2, s[36:39], s52 offen offset:2048 sc1
    buffer_load_dwordx4 v[212:215], v2, s[36:39], s53 offen offset:2048 sc1
    s_waitcnt lgkmcnt(0)
    s_barrier
    ds_read_b128 v[16:19], v10 offset:0
    ds_read_b128 v[20:23], v10 offset:1024
    ds_read_b128 v[24:27], v10 offset:2048
    ds_read_b128 v[28:31], v10 offset:3072
    ds_read_b128 v[32:35], v10 offset:4096
    ds_read_b128 v[36:39], v10 offset:5120
    ds_read_b128 v[40:43], v10 offset:6144
    ds_read_b128 v[44:47], v10 offset:7168
    s_waitcnt lgkmcnt(7)
    v_mfma_f32_32x32x16_bf16 v[128:143], v[96:99], v[16:19], v[128:143]
    s_waitcnt lgkmcnt(6)
    v_mfma_f32_32x32x16_bf16 v[128:143], v[100:103], v[20:23], v[128:143]
    ds_read_b128 v[64:67], v12 offset:0
    ds_read_b128 v[68:71], v12 offset:2112
    buffer_load_dwordx4 v[216:219], v2, s[36:39], s52 offen offset:3072 sc1
    s_add_u32 s52, s52, 4096
    s_waitcnt lgkmcnt(7)
    v_mfma_f32_32x32x16_bf16 v[144:159], v[104:107], v[24:27], v[144:159]
    s_waitcnt lgkmcnt(6)
    v_mfma_f32_32x32x16_bf16 v[144:159], v[108:111], v[28:31], v[144:159]
    ds_read_b128 v[72:75], v12 offset:32
    ds_read_b128 v[76:79], v12 offset:2144
    buffer_load_dwordx4 v[220:223], v2, s[36:39], s53 offen offset:3072 sc1
    s_add_u32 s53, s53, 4096
    s_waitcnt lgkmcnt(7)
    v_mfma_f32_32x32x16_bf16 v[160:175], v[112:115], v[32:35], v[160:175]
    s_waitcnt lgkmcnt(6)
    v_mfma_f32_32x32x16_bf16 v[160:175], v[116:119], v[36:39], v[160:175]
    ds_read_b128 v[80:83], v12 offset:64
    ds_read_b128 v[84:87], v12 offset:2176
    buffer_load_dwordx4 v[224:227], v2, s[36:39], s52 offen offset:0 sc1
    s_waitcnt lgkmcnt(7)
    v_mfma_f32_32x32x16_bf16 v[176:191], v[120:123], v[40:43], v[176:191]
    s_waitcnt lgkmcnt(6)
    v_mfma_f32_32x32x16_bf16 v[176:191], v[124:127], v[44:47], v[176:191]
    ds_read_b128 v[88:91], v12 offset:96
    ds_read_b128 v[92:95], v12 offset:2208
    buffer_load_dwordx4 v[228:231], v2, s[36:39], s53 offen offset:0 sc1
    v_mov_b32 v44, -1
    v_mov_b32 v45, -1
    v_mov_b32 v46, -1
    v_mov_b32 v47, -1
    v_pk_add_f32 v[48:49], v[128:129], v[130:131]
    v_pk_mul_f32 v[50:51], v[128:129], v[128:129]
    v_pk_add_f32 v[52:53], v[132:133], v[134:135]
    v_pk_mul_f32 v[54:55], v[130:131], v[130:131]
    v_pk_fma_f32 v[50:51], v[132:133], v[132:133], v[50:51]
    v_pk_fma_f32 v[54:55], v[134:135], v[134:135], v[54:55]
    v_pk_add_f32 v[48:49], v[48:49], v[136:137]
    v_pk_fma_f32 v[50:51], v[136:137], v[136:137], v[50:51]
    v_pk_add_f32 v[52:53], v[52:53], v[138:139]
    ds_read_b128 v[96:99], v12 offset:128
    buffer_store_dwordx4 v[44:47], v2, s[12:15], s24 offen offset:0 sc1
    ds_read_b128 v[100:103], v12 offset:2240
    v_pk_fma_f32 v[54:55], v[138:139], v[138:139], v[54:55]
    v_pk_add_f32 v[48:49], v[48:49], v[140:141]
    v_pk_fma_f32 v[50:51], v[140:141], v[140:141], v[50:51]
    v_pk_add_f32 v[52:53], v[52:53], v[142:143]
    v_pk_fma_f32 v[54:55], v[142:143], v[142:143], v[54:55]
    ds_read_b128 v[104:107], v12 offset:160
    ds_read_b128 v[108:111], v12 offset:2272
    v_pk_add_f32 v[48:49], v[48:49], v[144:145]
    v_pk_fma_f32 v[50:51], v[144:145], v[144:145], v[50:51]
    buffer_store_dwordx4 v[44:47], v2, s[12:15], s24 offen offset:1024 sc1
    v_pk_add_f32 v[52:53], v[52:53], v[146:147]
    v_pk_fma_f32 v[54:55], v[146:147], v[146:147], v[54:55]
    v_pk_add_f32 v[48:49], v[48:49], v[148:149]
    ds_read_b128 v[112:115], v12 offset:192
    ds_read_b128 v[116:119], v12 offset:2304
    v_pk_fma_f32 v[50:51], v[148:149], v[148:149], v[50:51]
    v_pk_add_f32 v[52:53], v[52:53], v[150:151]
    v_pk_fma_f32 v[54:55], v[150:151], v[150:151], v[54:55]
    v_pk_add_f32 v[48:49], v[48:49], v[152:153]
    v_pk_fma_f32 v[50:51], v[152:153], v[152:153], v[50:51]
    buffer_store_dwordx4 v[44:47], v2, s[12:15], s25 offen offset:0 sc1
    ds_read_b128 v[120:123], v12 offset:224
    ds_read_b128 v[124:127], v12 offset:2336
    v_pk_add_f32 v[52:53], v[52:53], v[154:155]
    v_pk_fma_f32 v[54:55], v[154:155], v[154:155], v[54:55]
    v_pk_add_f32 v[48:49], v[48:49], v[156:157]
    v_pk_fma_f32 v[50:51], v[156:157], v[156:157], v[50:51]
    v_pk_add_f32 v[52:53], v[52:53], v[158:159]
    v_pk_fma_f32 v[54:55], v[158:159], v[158:159], v[54:55]
    v_pk_add_f32 v[48:49], v[48:49], v[160:161]
    v_pk_fma_f32 v[50:51], v[160:161], v[160:161], v[50:51]
    buffer_store_dwordx4 v[44:47], v2, s[12:15], s25 offen offset:1024 sc1
    v_pk_add_f32 v[52:53], v[52:53], v[162:163]
    v_pk_fma_f32 v[54:55], v[162:163], v[162:163], v[54:55]
    v_pk_add_f32 v[48:49], v[48:49], v[164:165]
    v_pk_fma_f32 v[50:51], v[164:165], v[164:165], v[50:51]
    v_pk_add_f32 v[52:53], v[52:53], v[166:167]
    v_pk_fma_f32 v[54:55], v[166:167], v[166:167], v[54:55]
    v_pk_add_f32 v[48:49], v[48:49], v[168:169]
    v_pk_fma_f32 v[50:51], v[168:169], v[168:169], v[50:51]
    v_pk_add_f32 v[52:53], v[52:53], v[170:171]
    v_pk_fma_f32 v[54:55], v[170:171], v[170:171], v[54:55]
    buffer_store_dwordx4 v[44:47], v2, s[12:15], s26 offen offset:0 sc1
    v_pk_add_f32 v[48:49], v[48:49], v[172:173]
    v_pk_fma_f32 v[50:51], v[172:173], v[172:173], v[50:51]
    v_pk_add_f32 v[52:53], v[52:53], v[174:175]
    v_pk_fma_f32 v[54:55], v[174:175], v[174:175], v[54:55]
    v_pk_add_f32 v[48:49], v[48:49], v[176:177]
    v_pk_fma_f32 v[50:51], v[176:177], v[176:177], v[50:51]
    v_pk_add_f32 v[52:53], v[52:53], v[178:179]
    v_pk_fma_f32 v[54:55], v[178:179], v[178:179], v[54:55]
    v_pk_add_f32 v[48:49], v[48:49], v[180:181]
    v_pk_fma_f32 v[50:51], v[180:181], v[180:181], v[50:51]
    buffer_store_dwordx4 v[44:47], v2, s[12:15], s26 offen offset:1024 sc1
    v_pk_add_f32 v[52:53], v[52:53], v[182:183]
    v_pk_fma_f32 v[54:55], v[182:183], v[182:183], v[54:55]
    v_pk_add_f32 v[48:49], v[48:49], v[184:185]
    v_pk_fma_f32 v[50:51], v[184:185], v[184:185], v[50:51]
    v_pk_add_f32 v[52:53], v[52:53], v[186:187]
    v_pk_fma_f32 v[54:55], v[186:187], v[186:187], v[54:55]
    v_pk_add_f32 v[48:49], v[48:49], v[188:189]
    v_pk_fma_f32 v[50:51], v[188:189], v[188:189], v[50:51]
    v_pk_add_f32 v[52:53], v[52:53], v[190:191]
    v_pk_fma_f32 v[54:55], v[190:191], v[190:191], v[54:55]
    v_pk_add_f32 v[48:49], v[48:49], v[52:53]
    v_pk_add_f32 v[50:51], v[50:51], v[54:55]
    v_add_f32 v48, v48, v49
    v_add_f32 v49, v50, v51
    ds_write_b64 v11, v[48:49] offset:33280
    buffer_load_dwordx4 v[232:235], v2, s[36:39], s52 offen offset:1024 sc1
    buffer_load_dwordx4 v[236:239], v2, s[36:39], s53 offen offset:1024 sc1
    buffer_load_dwordx4 v[240:243], v2, s[36:39], s52 offen offset:2048 sc1
    s_waitcnt lgkmcnt(0)
    s_barrier
    ds_read_b128 v[48:51], v7 offset:33280
    ds_read_b128 v[52:55], v7 offset:33296
    ds_read_b128 v[56:59], v7 offset:33312
    ds_read_b128 v[60:63], v7 offset:33328
    v_add_u32 v10, s72, v2
    v_add_u32 v13, s74, v2
    v_and_b32 v11, 3, v3
    v_lshl_add_u32 v11, v11, 7, s78
    s_waitcnt lgkmcnt(3)
    v_pk_add_f32 v[48:49], v[48:49], v[50:51]
    s_waitcnt lgkmcnt(2)
    v_pk_add_f32 v[52:53], v[52:53], v[54:55]
    s_waitcnt lgkmcnt(1)
    v_pk_add_f32 v[56:57], v[56:57], v[58:59]
    s_waitcnt lgkmcnt(0)
    v_pk_add_f32 v[60:61], v[60:61], v[62:63]
    v_pk_add_f32 v[48:49], v[48:49], v[52:53]
    v_pk_add_f32 v[56:57], v[56:57], v[60:61]
    v_pk_add_f32 v[48:49], v[48:49], v[56:57]
    v_mul_f32 v48, 0x3b000000, v48
    v_mul_f32 v49, 0x3b000000, v49
    v_fma_f32 v49, -v48, v48, v49
    v_max_f32 v49, 0, v49
    v_add_f32 v49, 0x3727c5ac, v49
    v_rsq_f32 v14, v49
    s_nop 0
    v_mul_f32 v15, -v48, v14
    v_mov_b32 v56, v5
    v_mov_b32 v57, 0
    v_mov_b32 v58, 0
    v_mov_b32 v59, 0
    v_pk_fma_f32 v[48:49], v[128:129], v[14:15], v[14:15] op_sel:[0,0,1] op_sel_hi:[1,0,1]
    v_pk_fma_f32 v[50:51], v[130:131], v[14:15], v[14:15] op_sel:[0,0,1] op_sel_hi:[1,0,1]
    v_pk_fma_f32 v[48:49], v[48:49], v[68:69], v[64:65]
    v_pk_fma_f32 v[50:51], v[50:51], v[70:71], v[66:67]
    ds_read_b128 v[64:67], v12 offset:256
    ds_read_b128 v[68:71], v12 offset:2368
    v_cvt_pk_bf16_f32 v16, v48, v49
    v_cvt_pk_bf16_f32 v17, v50, v51
    v_pk_fma_f32 v[52:53], v[132:133], v[14:15], v[14:15] op_sel:[0,0,1] op_sel_hi:[1,0,1]
    v_pk_fma_f32 v[54:55], v[134:135], v[14:15], v[14:15] op_sel:[0,0,1] op_sel_hi:[1,0,1]
    v_pk_fma_f32 v[52:53], v[52:53], v[76:77], v[72:73]
    v_pk_fma_f32 v[54:55], v[54:55], v[78:79], v[74:75]
    ds_read_b128 v[72:75], v12 offset:288
    ds_read_b128 v[76:79], v12 offset:2400
    v_cvt_pk_bf16_f32 v18, v52, v53
    v_cvt_pk_bf16_f32 v19, v54, v55
    ds_write_b128 v8, v[16:19] offset:0
    v_pk_fma_f32 v[48:49], v[136:137], v[14:15], v[14:15] op_sel:[0,0,1] op_sel_hi:[1,0,1]
    v_pk_fma_f32 v[50:51], v[138:139], v[14:15], v[14:15] op_sel:[0,0,1] op_sel_hi:[1,0,1]
    buffer_load_dwordx4 v[244:247], v2, s[36:39], s53 offen offset:2048 sc1
    v_pk_fma_f32 v[48:49], v[48:49], v[84:85], v[80:81]
    v_pk_fma_f32 v[50:51], v[50:51], v[86:87], v[82:83]
    ds_read_b128 v[80:83], v12 offset:320
    ds_read_b128 v[84:87], v12 offset:2432
    v_cvt_pk_bf16_f32 v20, v48, v49
    v_cvt_pk_bf16_f32 v21, v50, v51
    v_pk_fma_f32 v[52:53], v[140:141], v[14:15], v[14:15] op_sel:[0,0,1] op_sel_hi:[1,0,1]
    v_pk_fma_f32 v[54:55], v[142:143], v[14:15], v[14:15] op_sel:[0,0,1] op_sel_hi:[1,0,1]
    v_pk_fma_f32 v[52:53], v[52:53], v[92:93], v[88:89]
    v_pk_fma_f32 v[54:55], v[54:55], v[94:95], v[90:91]
    ds_read_b128 v[88:91], v12 offset:352
    ds_read_b128 v[92:95], v12 offset:2464
    v_cvt_pk_bf16_f32 v22, v52, v53
    v_cvt_pk_bf16_f32 v23, v54, v55
    ds_write_b128 v8, v[20:23] offset:1024
    v_pk_fma_f32 v[48:49], v[144:145], v[14:15], v[14:15] op_sel:[0,0,1] op_sel_hi:[1,0,1]
    v_pk_fma_f32 v[50:51], v[146:147], v[14:15], v[14:15] op_sel:[0,0,1] op_sel_hi:[1,0,1]
    v_pk_fma_f32 v[48:49], v[48:49], v[100:101], v[96:97]
    v_pk_fma_f32 v[50:51], v[50:51], v[102:103], v[98:99]
    ds_read_b128 v[96:99], v12 offset:384
    ds_read_b128 v[100:103], v12 offset:2496
    v_cvt_pk_bf16_f32 v24, v48, v49
    buffer_load_dwordx4 v[248:251], v2, s[36:39], s52 offen offset:3072 sc1
    s_add_u32 s52, s52, 4096
    v_cvt_pk_bf16_f32 v25, v50, v51
    v_pk_fma_f32 v[52:53], v[148:149], v[14:15], v[14:15] op_sel:[0,0,1] op_sel_hi:[1,0,1]
    v_pk_fma_f32 v[54:55], v[150:151], v[14:15], v[14:15] op_sel:[0,0,1] op_sel_hi:[1,0,1]
    v_pk_fma_f32 v[52:53], v[52:53], v[108:109], v[104:105]
    v_pk_fma_f32 v[54:55], v[54:55], v[110:111], v[106:107]
    ds_read_b128 v[104:107], v12 offset:416
    ds_read_b128 v[108:111], v12 offset:2528
    v_cvt_pk_bf16_f32 v26, v52, v53
    v_cvt_pk_bf16_f32 v27, v54, v55
    ds_write_b128 v8, v[24:27] offset:2048
    v_pk_fma_f32 v[48:49], v[152:153], v[14:15], v[14:15] op_sel:[0,0,1] op_sel_hi:[1,0,1]
    v_pk_fma_f32 v[50:51], v[154:155], v[14:15], v[14:15] op_sel:[0,0,1] op_sel_hi:[1,0,1]
    v_pk_fma_f32 v[48:49], v[48:49], v[116:117], v[112:113]
    v_pk_fma_f32 v[50:51], v[50:51], v[118:119], v[114:115]
    ds_read_b128 v[112:115], v12 offset:448
    ds_read_b128 v[116:119], v12 offset:2560
    v_cvt_pk_bf16_f32 v28, v48, v49
    v_cvt_pk_bf16_f32 v29, v50, v51
    v_pk_fma_f32 v[52:53], v[156:157], v[14:15], v[14:15] op_sel:[0,0,1] op_sel_hi:[1,0,1]
    v_pk_fma_f32 v[54:55], v[158:159], v[14:15], v[14:15] op_sel:[0,0,1] op_sel_hi:[1,0,1]
    v_pk_fma_f32 v[52:53], v[52:53], v[124:125], v[120:121]
    v_pk_fma_f32 v[54:55], v[54:55], v[126:127], v[122:123]
    ds_read_b128 v[120:123], v12 offset:480
    buffer_load_dwordx4 v[252:255], v2, s[36:39], s53 offen offset:3072 sc1
    s_add_u32 s53, s53, 4096
    ds_read_b128 v[124:127], v12 offset:2592
    v_cvt_pk_bf16_f32 v30, v52, v53
    v_cvt_pk_bf16_f32 v31, v54, v55
    ds_write_b128 v8, v[28:31] offset:3072
    v_pk_fma_f32 v[48:49], v[160:161], v[14:15], v[14:15] op_sel:[0,0,1] op_sel_hi:[1,0,1]
    v_pk_fma_f32 v[50:51], v[162:163], v[14:15], v[14:15] op_sel:[0,0,1] op_sel_hi:[1,0,1]
    s_waitcnt lgkmcnt(15)
    v_pk_fma_f32 v[48:49], v[48:49], v[68:69], v[64:65]
    v_pk_fma_f32 v[50:51], v[50:51], v[70:71], v[66:67]
    v_cvt_pk_bf16_f32 v32, v48, v49
    v_cvt_pk_bf16_f32 v33, v50, v51
    v_pk_fma_f32 v[52:53], v[164:165], v[14:15], v[14:15] op_sel:[0,0,1] op_sel_hi:[1,0,1]
    v_pk_fma_f32 v[54:55], v[166:167], v[14:15], v[14:15] op_sel:[0,0,1] op_sel_hi:[1,0,1]
    v_pk_fma_f32 v[52:53], v[52:53], v[76:77], v[72:73]
    v_pk_fma_f32 v[54:55], v[54:55], v[78:79], v[74:75]
    v_cvt_pk_bf16_f32 v34, v52, v53
    v_cvt_pk_bf16_f32 v35, v54, v55
    ds_write_b128 v8, v[32:35] offset:4096
    v_pk_fma_f32 v[48:49], v[168:169], v[14:15], v[14:15] op_sel:[0,0,1] op_sel_hi:[1,0,1]
    v_pk_fma_f32 v[50:51], v[170:171], v[14:15], v[14:15] op_sel:[0,0,1] op_sel_hi:[1,0,1]
    s_waitcnt lgkmcnt(14)
    v_pk_fma_f32 v[48:49], v[48:49], v[84:85], v[80:81]
    v_pk_fma_f32 v[50:51], v[50:51], v[86:87], v[82:83]
    v_cvt_pk_bf16_f32 v36, v48, v49
    v_cvt_pk_bf16_f32 v37, v50, v51
    v_pk_fma_f32 v[52:53], v[172:173], v[14:15], v[14:15] op_sel:[0,0,1] op_sel_hi:[1,0,1]
    v_pk_fma_f32 v[54:55], v[174:175], v[14:15], v[14:15] op_sel:[0,0,1] op_sel_hi:[1,0,1]
    s_waitcnt lgkmcnt(12)
    v_pk_fma_f32 v[52:53], v[52:53], v[92:93], v[88:89]
    v_pk_fma_f32 v[54:55], v[54:55], v[94:95], v[90:91]
    v_cvt_pk_bf16_f32 v38, v52, v53
    v_cvt_pk_bf16_f32 v39, v54, v55
    ds_write_b128 v8, v[36:39] offset:5120
    v_pk_fma_f32 v[48:49], v[176:177], v[14:15], v[14:15] op_sel:[0,0,1] op_sel_hi:[1,0,1]
    v_pk_fma_f32 v[50:51], v[178:179], v[14:15], v[14:15] op_sel:[0,0,1] op_sel_hi:[1,0,1]
    s_waitcnt lgkmcnt(10)
    v_pk_fma_f32 v[48:49], v[48:49], v[100:101], v[96:97]
    v_pk_fma_f32 v[50:51], v[50:51], v[102:103], v[98:99]
    v_cvt_pk_bf16_f32 v40, v48, v49
    v_cvt_pk_bf16_f32 v41, v50, v51
    v_pk_fma_f32 v[52:53], v[180:181], v[14:15], v[14:15] op_sel:[0,0,1] op_sel_hi:[1,0,1]
    v_pk_fma_f32 v[54:55], v[182:183], v[14:15], v[14:15] op_sel:[0,0,1] op_sel_hi:[1,0,1]
    s_waitcnt lgkmcnt(8)
    v_pk_fma_f32 v[52:53], v[52:53], v[108:109], v[104:105]
    v_pk_fma_f32 v[54:55], v[54:55], v[110:111], v[106:107]
    v_cvt_pk_bf16_f32 v42, v52, v53
    v_cvt_pk_bf16_f32 v43, v54, v55
    ds_write_b128 v8, v[40:43] offset:6144
    v_pk_fma_f32 v[48:49], v[184:185], v[14:15], v[14:15] op_sel:[0,0,1] op_sel_hi:[1,0,1]
    v_pk_fma_f32 v[50:51], v[186:187], v[14:15], v[14:15] op_sel:[0,0,1] op_sel_hi:[1,0,1]
    s_waitcnt lgkmcnt(6)
    v_pk_fma_f32 v[48:49], v[48:49], v[116:117], v[112:113]
    v_pk_fma_f32 v[50:51], v[50:51], v[118:119], v[114:115]
    v_cvt_pk_bf16_f32 v44, v48, v49
    v_cvt_pk_bf16_f32 v45, v50, v51
    v_pk_fma_f32 v[52:53], v[188:189], v[14:15], v[14:15] op_sel:[0,0,1] op_sel_hi:[1,0,1]
    v_pk_fma_f32 v[54:55], v[190:191], v[14:15], v[14:15] op_sel:[0,0,1] op_sel_hi:[1,0,1]
    s_waitcnt lgkmcnt(4)
    v_pk_fma_f32 v[52:53], v[52:53], v[124:125], v[120:121]
    v_pk_fma_f32 v[54:55], v[54:55], v[126:127], v[122:123]
    v_cvt_pk_bf16_f32 v46, v52, v53
    v_cvt_pk_bf16_f32 v47, v54, v55
    ds_write_b128 v8, v[44:47] offset:7168
    v_mov_b32 v60, 0x3f803f80
    v_mov_b32 v61, 0x3f803f80
    v_mov_b32 v62, 0x3f803f80
    v_mov_b32 v63, 0x3f803f80
    v_add_u32 v12, s73, v2
    s_nop 0
    v_mfma_f32_32x32x16_bf16 v[64:79], v[56:59], v[60:63], 0
    v_mov_b32 v56, v6
    s_getreg_b32 s29, hwreg(HW_REG_XCC_ID)
    v_mov_b32 v1, 0
    v_mov_b32 v14, s94
    v_mov_b32 v15, s29
    v_mfma_f32_32x32x16_bf16 v[80:95], v[56:59], v[60:63], 0
    v_mov_b32 v56, v0
    v_add_u32 v7, 60672, v2
    s_waitcnt vmcnt(6)
    v_mfma_f32_32x32x16_bf16 v[96:111], v[56:59], v[60:63], 0
    s_mov_b64 exec, 1
    buffer_store_dwordx2 v[14:15], v1, s[12:15], s77 offen sc1
    s_mov_b64 exec, -1
    s_waitcnt lgkmcnt(0)
    s_barrier
    s_cmp_eq_u32 s3, 3
    s_cbranch_scc1 L_p0b
L_p0b_back:
    ds_read_b128 v[16:19], v2 offset:0
    ds_read_b128 v[40:43], v10 offset:0
    ds_read_b128 v[20:23], v2 offset:1024
    ds_read_b128 v[44:47], v10 offset:1024
    ds_read_b128 v[24:27], v2 offset:2048
    ds_read_b128 v[48:51], v10 offset:2048
    ds_read_b128 v[28:31], v2 offset:3072
    ds_read_b128 v[52:55], v10 offset:3072
    ds_read_b128 v[32:35], v2 offset:4096
    ds_read_b128 v[56:59], v10 offset:4096
    s_waitcnt lgkmcnt(6)
    v_mfma_f32_32x32x16_bf16 v[64:79], v[40:43], v[16:19], v[64:79]
    ds_read_b128 v[36:39], v2 offset:5120
    ds_read_b128 v[60:63], v10 offset:5120
    v_mfma_f32_32x32x16_bf16 v[64:79], v[44:47], v[20:23], v[64:79]
    ds_read_b128 v[16:19], v2 offset:6144
    ds_read_b128 v[40:43], v10 offset:6144
    s_waitcnt lgkmcnt(6)
    v_mfma_f32_32x32x16_bf16 v[64:79], v[48:51], v[24:27], v[64:79]
    ds_read_b128 v[20:23], v2 offset:7168
    ds_read_b128 v[44:47], v10 offset:7168
    s_set_gpr_idx_on s28, gpr_idx(SRC0)
    s_nop 0
    v_mov_b32 v112, v128
    v_mov_b32 v113, v144
    v_mov_b32 v114, v160
    v_mov_b32 v115, v176
    s_set_gpr_idx_off
    ds_write_b128 v9, v[112:115] offset:35840
    v_mfma_f32_32x32x16_bf16 v[64:79], v[52:55], v[28:31], v[64:79]
    ds_read_b128 v[24:27], v2 offset:8192
    ds_read_b128 v[48:51], v10 offset:8192
    s_waitcnt lgkmcnt(7)
    v_mfma_f32_32x32x16_bf16 v[64:79], v[56:59], v[32:35], v[64:79]
    ds_read_b128 v[28:31], v2 offset:9216
    ds_read_b128 v[52:55], v10 offset:9216
    s_set_gpr_idx_on s28, gpr_idx(SRC0)
    s_nop 0
    v_mov_b32 v116, v129
    v_mov_b32 v117, v145
    v_mov_b32 v118, v161
    v_mov_b32 v119, v177
    s_set_gpr_idx_off
    ds_write_b128 v9, v[116:119] offset:36352
    v_mfma_f32_32x32x16_bf16 v[64:79], v[60:63], v[36:39], v[64:79]
    ds_read_b128 v[32:35], v2 offset:10240
    ds_read_b128 v[56:59], v10 offset:10240
    s_set_gpr_idx_on s28, gpr_idx(SRC0)
    s_nop 0
    v_mov_b32 v120, v130
    v_mov_b32 v121, v146
    v_mov_b32 v122, v162
    v_mov_b32 v123, v178
    s_set_gpr_idx_off
    ds_write_b128 v9, v[120:123] offset:39936
    s_waitcnt lgkmcnt(9)
    v_mfma_f32_32x32x16_bf16 v[64:79], v[40:43], v[16:19], v[64:79]
    ds_read_b128 v[36:39], v2 offset:11264
    ds_read_b128 v[60:63], v10 offset:11264
    v_mfma_f32_32x32x16_bf16 v[64:79], v[44:47], v[20:23], v[64:79]
    ds_read_b128 v[16:19], v2 offset:12288
    ds_read_b128 v[40:43], v10 offset:12288
    s_set_gpr_idx_on s28, gpr_idx(SRC0)
    s_nop 0
    v_mov_b32 v124, v131
    v_mov_b32 v125, v147
    v_mov_b32 v126, v163
    v_mov_b32 v127, v179
    s_set_gpr_idx_off
    ds_write_b128 v9, v[124:127] offset:40448
    s_waitcnt lgkmcnt(9)
    v_mfma_f32_32x32x16_bf16 v[64:79], v[48:51], v[24:27], v[64:79]
    ds_read_b128 v[20:23], v2 offset:13312
    ds_read_b128 v[44:47], v10 offset:13312
    buffer_load_dwordx4 v[128:131], v2, s[36:39], s52 offen offset:0 sc1
    v_mfma_f32_32x32x16_bf16 v[64:79], v[52:55], v[28:31], v[64:79]
    ds_read_b128 v[24:27], v2 offset:14336
    ds_read_b128 v[48:51], v10 offset:14336
    buffer_load_dwordx4 v[132:135], v2, s[36:39], s53 offen offset:0 sc1
    s_waitcnt lgkmcnt(7)
    v_mfma_f32_32x32x16_bf16 v[64:79], v[56:59], v[32:35], v[64:79]
    ds_read_b128 v[28:31], v2 offset:15360
    ds_read_b128 v[52:55], v10 offset:15360
    v_mfma_f32_32x32x16_bf16 v[64:79], v[60:63], v[36:39], v[64:79]
    ds_read_b128 v[32:35], v2 offset:16384
    ds_read_b128 v[56:59], v10 offset:16384
    buffer_load_dwordx4 v[136:139], v2, s[36:39], s52 offen offset:1024 sc1
    s_waitcnt lgkmcnt(6)
    v_mfma_f32_32x32x16_bf16 v[64:79], v[40:43], v[16:19], v[64:79]
    ds_read_b128 v[36:39], v2 offset:17408
    ds_read_b128 v[60:63], v10 offset:17408
    v_mfma_f32_32x32x16_bf16 v[64:79], v[44:47], v[20:23], v[64:79]
    ds_read_b128 v[16:19], v2 offset:18432
    ds_read_b128 v[40:43], v10 offset:18432
    buffer_load_dwordx4 v[140:143], v2, s[36:39], s53 offen offset:1024 sc1
    s_waitcnt lgkmcnt(6)
    v_mfma_f32_32x32x16_bf16 v[64:79], v[48:51], v[24:27], v[64:79]
    ds_read_b128 v[20:23], v2 offset:19456
    ds_read_b128 v[44:47], v10 offset:19456
    v_mfma_f32_32x32x16_bf16 v[64:79], v[52:55], v[28:31], v[64:79]
    ds_read_b128 v[24:27], v2 offset:20480
    ds_read_b128 v[48:51], v10 offset:20480
    buffer_load_dwordx4 v[144:147], v2, s[36:39], s52 offen offset:2048 sc1
    s_waitcnt lgkmcnt(6)
    v_mfma_f32_32x32x16_bf16 v[64:79], v[56:59], v[32:35], v[64:79]
    ds_read_b128 v[28:31], v2 offset:21504
    ds_read_b128 v[52:55], v10 offset:21504
    buffer_load_dwordx4 v[148:151], v2, s[36:39], s53 offen offset:2048 sc1
    v_mfma_f32_32x32x16_bf16 v[64:79], v[60:63], v[36:39], v[64:79]
    ds_read_b128 v[32:35], v2 offset:22528
    ds_read_b128 v[56:59], v10 offset:22528
    s_waitcnt lgkmcnt(6)
    v_mfma_f32_32x32x16_bf16 v[64:79], v[40:43], v[16:19], v[64:79]
    ds_read_b128 v[36:39], v2 offset:23552
    ds_read_b128 v[60:63], v10 offset:23552
    buffer_load_dwordx4 v[152:155], v2, s[36:39], s52 offen offset:3072 sc1
    s_add_u32 s52, s52, 4096
    v_mfma_f32_32x32x16_bf16 v[64:79], v[44:47], v[20:23], v[64:79]
    ds_read_b128 v[16:19], v2 offset:24576
    ds_read_b128 v[40:43], v10 offset:24576
    s_waitcnt lgkmcnt(6)
    v_mfma_f32_32x32x16_bf16 v[64:79], v[48:51], v[24:27], v[64:79]
    ds_read_b128 v[20:23], v2 offset:25600
    ds_read_b128 v[44:47], v10 offset:25600
    buffer_load_dwordx4 v[156:159], v2, s[36:39], s53 offen offset:3072 sc1
    s_add_u32 s53, s53, 4096
    v_mfma_f32_32x32x16_bf16 v[64:79], v[52:55], v[28:31], v[64:79]
    ds_read_b128 v[24:27], v2 offset:26624
    ds_read_b128 v[48:51], v10 offset:26624
    s_waitcnt lgkmcnt(6)
    v_mfma_f32_32x32x16_bf16 v[64:79], v[56:59], v[32:35], v[64:79]
    ds_read_b128 v[28:31], v2 offset:27648
    ds_read_b128 v[52:55], v10 offset:27648
    buffer_load_dwordx4 v[160:163], v2, s[36:39], s52 offen offset:0 sc1
    v_mfma_f32_32x32x16_bf16 v[64:79], v[60:63], v[36:39], v[64:79]
    ds_read_b128 v[32:35], v2 offset:28672
    ds_read_b128 v[56:59], v10 offset:28672
    s_waitcnt lgkmcnt(6)
    v_mfma_f32_32x32x16_bf16 v[64:79], v[40:43], v[16:19], v[64:79]
    ds_read_b128 v[36:39], v2 offset:29696
    ds_read_b128 v[60:63], v10 offset:29696
    buffer_load_dwordx4 v[164:167], v2, s[36:39], s53 offen offset:0 sc1
    v_mfma_f32_32x32x16_bf16 v[64:79], v[44:47], v[20:23], v[64:79]
    ds_read_b128 v[16:19], v2 offset:30720
    ds_read_b128 v[40:43], v10 offset:30720
    buffer_load_dwordx4 v[168:171], v2, s[36:39], s52 offen offset:1024 sc1
    s_waitcnt lgkmcnt(6)
    v_mfma_f32_32x32x16_bf16 v[64:79], v[48:51], v[24:27], v[64:79]
    ds_read_b128 v[20:23], v2 offset:31744
    ds_read_b128 v[44:47], v10 offset:31744
    v_mfma_f32_32x32x16_bf16 v[64:79], v[52:55], v[28:31], v[64:79]
    ds_read_b128 v[24:27], v2 offset:0
    buffer_load_dwordx4 v[172:175], v2, s[36:39], s53 offen offset:1024 sc1
    s_waitcnt lgkmcnt(5)
    v_mfma_f32_32x32x16_bf16 v[64:79], v[56:59], v[32:35], v[64:79]
    ds_read_b128 v[28:31], v2 offset:1024
    v_mfma_f32_32x32x16_bf16 v[64:79], v[60:63], v[36:39], v[64:79]
    ds_read_b128 v[32:35], v2 offset:2048
    buffer_load_dwordx4 v[176:179], v2, s[36:39], s52 offen offset:2048 sc1
    s_waitcnt lgkmcnt(3)
    v_mfma_f32_32x32x16_bf16 v[64:79], v[40:43], v[16:19], v[64:79]
    ds_read_b128 v[36:39], v2 offset:3072
    v_mfma_f32_32x32x16_bf16 v[64:79], v[44:47], v[20:23], v[64:79]
    ds_read_b128 v[16:19], v2 offset:4096
    buffer_load_dwordx4 v[180:183], v2, s[36:39], s52 offen offset:3072 sc1
    s_add_u32 s52, s52, 4096
L_p0e:
    s_barrier
    s_waitcnt lgkmcnt(0)
    v_mfma_f32_32x32x16_bf16 v[80:95], a[0:3], v[24:27], v[80:95]
    ds_read_b128 v[20:23], v2 offset:5120
    v_mfma_f32_32x32x16_bf16 v[80:95], a[4:7], v[28:31], v[80:95]
    ds_read_b128 v[24:27], v2 offset:6144
    buffer_load_dwordx4 v[184:187], v2, s[36:39], s52 offen offset:0 sc1
    s_nop 4
    v_exp_f32 v52, v64
    v_mfma_f32_32x32x16_bf16 v[80:95], a[8:11], v[32:35], v[80:95]
    ds_read_b128 v[28:31], v2 offset:7168
    buffer_load_dwordx4 v[188:191], v2, s[36:39], s52 offen offset:1024 sc1
    v_exp_f32 v53, v65
    v_fma_f32 v48, v52, -0.5, -1.0
    v_fma_f32 v48, v52, v48, -1.0
    v_mfma_f32_32x32x16_bf16 v[80:95], a[12:15], v[36:39], v[80:95]
    ds_read_b128 v[32:35], v2 offset:8192
    v_rcp_f32 v48, v48
    s_waitcnt lgkmcnt(3)
    v_mfma_f32_32x32x16_bf16 v[80:95], a[16:19], v[16:19], v[80:95]
    ds_read_b128 v[36:39], v2 offset:9216
    buffer_load_dwordx4 a[0:3], v2, s[36:39], s52 offen offset:2048 sc1
    v_exp_f32 v54, v66
    v_fma_f32 v49, v53, -0.5, -1.0
    v_fma_f32 v49, v53, v49, -1.0
    v_mfma_f32_32x32x16_bf16 v[80:95], a[20:23], v[20:23], v[80:95]
    ds_read_b128 v[16:19], v2 offset:10240
    buffer_load_dwordx4 a[4:7], v2, s[36:39], s52 offen offset:3072 sc1
    s_add_u32 s52, s52, 4096
    v_rcp_f32 v49, v49
    v_fma_f32 v48, v64, v48, v64
    s_waitcnt lgkmcnt(3)
    v_mfma_f32_32x32x16_bf16 v[80:95], a[24:27], v[24:27], v[80:95]
    ds_read_b128 v[20:23], v2 offset:11264
    v_exp_f32 v55, v67
    v_fma_f32 v50, v54, -0.5, -1.0
    v_fma_f32 v50, v54, v50, -1.0
    v_rcp_f32 v50, v50
    v_fma_f32 v49, v65, v49, v65
    v_mfma_f32_32x32x16_bf16 v[80:95], a[28:31], v[28:31], v[80:95]
    ds_read_b128 v[24:27], v2 offset:12288
    buffer_load_dwordx4 a[8:11], v2, s[36:39], s52 offen offset:0 sc1
    v_exp_f32 v52, v68
    v_cvt_pk_bf16_f32 v56, v48, v49
    v_fma_f32 v51, v55, -0.5, -1.0
    v_fma_f32 v51, v55, v51, -1.0
    s_waitcnt lgkmcnt(3)
    v_mfma_f32_32x32x16_bf16 v[80:95], a[32:35], v[32:35], v[80:95]
    ds_read_b128 v[28:31], v2 offset:13312
    v_rcp_f32 v51, v51
    v_fma_f32 v50, v66, v50, v66
    v_mfma_f32_32x32x16_bf16 v[80:95], a[36:39], v[36:39], v[80:95]
    ds_read_b128 v[32:35], v2 offset:14336
    buffer_load_dwordx4 a[12:15], v2, s[36:39], s52 offen offset:1024 sc1
    v_exp_f32 v53, v69
    v_fma_f32 v48, v52, -0.5, -1.0
    v_fma_f32 v48, v52, v48, -1.0
    s_waitcnt lgkmcnt(3)
    v_mfma_f32_32x32x16_bf16 v[80:95], a[40:43], v[16:19], v[80:95]
    ds_read_b128 v[36:39], v2 offset:15360
    buffer_load_dwordx4 a[16:19], v2, s[36:39], s53 offen offset:2048 sc1
    v_rcp_f32 v48, v48
    v_fma_f32 v51, v67, v51, v67
    v_mfma_f32_32x32x16_bf16 v[80:95], a[44:47], v[20:23], v[80:95]
    ds_read_b128 v[16:19], v2 offset:16384
    v_exp_f32 v54, v70
    v_cvt_pk_bf16_f32 v57, v50, v51
    v_fma_f32 v49, v53, -0.5, -1.0
    v_fma_f32 v49, v53, v49, -1.0
    v_rcp_f32 v49, v49
    v_fma_f32 v48, v68, v48, v68
    s_waitcnt lgkmcnt(3)
    v_mfma_f32_32x32x16_bf16 v[80:95], a[48:51], v[24:27], v[80:95]
    ds_read_b128 v[20:23], v2 offset:17408
    buffer_load_dwordx4 a[20:23], v2, s[36:39], s53 offen offset:3072 sc1
    s_add_u32 s53, s53, 4096
    v_exp_f32 v55, v71
    v_fma_f32 v50, v54, -0.5, -1.0
    v_fma_f32 v50, v54, v50, -1.0
    v_mfma_f32_32x32x16_bf16 v[80:95], a[52:55], v[28:31], v[80:95]
    ds_read_b128 v[24:27], v2 offset:18432
    buffer_load_dwordx4 a[24:27], v2, s[36:39], s53 offen offset:0 sc1
    v_rcp_f32 v50, v50
    v_fma_f32 v49, v69, v49, v69
    s_waitcnt lgkmcnt(3)
    v_mfma_f32_32x32x16_bf16 v[80:95], a[56:59], v[32:35], v[80:95]
    ds_read_b128 v[28:31], v2 offset:19456
    v_exp_f32 v52, v72
    v_cvt_pk_bf16_f32 v58, v48, v49
    v_fma_f32 v51, v55, -0.5, -1.0
    v_fma_f32 v51, v55, v51, -1.0
    v_mfma_f32_32x32x16_bf16 v[80:95], a[60:63], v[36:39], v[80:95]
    ds_read_b128 v[32:35], v2 offset:20480
    buffer_load_dwordx4 a[28:31], v2, s[36:39], s53 offen offset:1024 sc1
    v_rcp_f32 v51, v51
    v_fma_f32 v50, v70, v50, v70
    s_waitcnt lgkmcnt(3)
    v_mfma_f32_32x32x16_bf16 v[80:95], a[64:67], v[16:19], v[80:95]
    ds_read_b128 v[36:39], v2 offset:21504
    v_exp_f32 v53, v73
    v_fma_f32 v48, v52, -0.5, -1.0
    v_fma_f32 v48, v52, v48, -1.0
    v_rcp_f32 v48, v48
    v_fma_f32 v51, v71, v51, v71
    v_mfma_f32_32x32x16_bf16 v[80:95], a[68:71], v[20:23], v[80:95]
    ds_read_b128 v[16:19], v2 offset:22528
    buffer_load_dwordx4 a[32:35], v2, s[36:39], s53 offen offset:2048 sc1
    v_exp_f32 v54, v74
    v_cvt_pk_bf16_f32 v59, v50, v51
    v_fma_f32 v49, v53, -0.5, -1.0
    v_fma_f32 v49, v53, v49, -1.0
    s_waitcnt lgkmcnt(3)
    v_mfma_f32_32x32x16_bf16 v[80:95], a[72:75], v[24:27], v[80:95]
    ds_read_b128 v[20:23], v2 offset:23552
    buffer_load_dwordx4 a[36:39], v2, s[36:39], s53 offen offset:3072 sc1
    s_add_u32 s53, s53, 4096
    v_rcp_f32 v49, v49
    v_fma_f32 v48, v72, v48, v72
    ds_write_b128 v13, v[56:59] offset:0
    v_mfma_f32_32x32x16_bf16 v[80:95], a[76:79], v[28:31], v[80:95]
    ds_read_b128 v[24:27], v2 offset:24576
    v_exp_f32 v55, v75
    v_fma_f32 v50, v54, -0.5, -1.0
    v_fma_f32 v50, v54, v50, -1.0
    s_waitcnt lgkmcnt(4)
    v_mfma_f32_32x32x16_bf16 v[80:95], a[80:83], v[32:35], v[80:95]
    ds_read_b128 v[28:31], v2 offset:25600
    buffer_load_dwordx4 a[40:43], v2, s[36:39], s53 offen offset:0 sc1
    v_rcp_f32 v50, v50
    v_fma_f32 v49, v73, v49, v73
    v_mfma_f32_32x32x16_bf16 v[80:95], a[84:87], v[36:39], v[80:95]
    ds_read_b128 v[32:35], v2 offset:26624
    buffer_load_dwordx4 a[44:47], v2, s[36:39], s53 offen offset:1024 sc1
    v_exp_f32 v52, v76
    v_cvt_pk_bf16_f32 v60, v48, v49
    v_fma_f32 v51, v55, -0.5, -1.0
    v_fma_f32 v51, v55, v51, -1.0
    v_rcp_f32 v51, v51
    v_fma_f32 v50, v74, v50, v74
    s_waitcnt lgkmcnt(4)
    v_mfma_f32_32x32x16_bf16 v[80:95], a[88:91], v[16:19], v[80:95]
    ds_read_b128 v[36:39], v2 offset:27648
    v_exp_f32 v53, v77
    v_fma_f32 v48, v52, -0.5, -1.0
    v_fma_f32 v48, v52, v48, -1.0
    v_mfma_f32_32x32x16_bf16 v[80:95], a[92:95], v[20:23], v[80:95]
    ds_read_b128 v[16:19], v2 offset:28672
    buffer_load_dwordx4 a[48:51], v2, s[36:39], s54 offen offset:0 sc1
    v_rcp_f32 v48, v48
    v_fma_f32 v51, v75, v51, v75
    s_waitcnt lgkmcnt(3)
    v_mfma_f32_32x32x16_bf16 v[80:95], a[96:99], v[24:27], v[80:95]
    ds_read_b128 v[20:23], v2 offset:29696
    v_exp_f32 v54, v78
    v_cvt_pk_bf16_f32 v61, v50, v51
    v_fma_f32 v49, v53, -0.5, -1.0
    v_fma_f32 v49, v53, v49, -1.0
    v_mfma_f32_32x32x16_bf16 v[80:95], a[100:103], v[28:31], v[80:95]
    ds_read_b128 v[24:27], v2 offset:30720
    buffer_load_dwordx4 a[52:55], v2, s[36:39], s54 offen offset:1024 sc1
    v_rcp_f32 v49, v49
    v_fma_f32 v48, v76, v48, v76
    s_waitcnt lgkmcnt(3)
    v_mfma_f32_32x32x16_bf16 v[80:95], a[104:107], v[32:35], v[80:95]
    ds_read_b128 v[28:31], v2 offset:31744
    buffer_load_dwordx4 a[56:59], v2, s[36:39], s54 offen offset:2048 sc1
    v_exp_f32 v55, v79
    v_fma_f32 v50, v54, -0.5, -1.0
    v_fma_f32 v50, v54, v50, -1.0
    v_rcp_f32 v50, v50
    v_fma_f32 v49, v77, v49, v77
    v_mfma_f32_32x32x16_bf16 v[80:95], a[108:111], v[36:39], v[80:95]
    ds_read_b128 v[32:35], v2 offset:0
    v_cvt_pk_bf16_f32 v62, v48, v49
    v_fma_f32 v51, v55, -0.5, -1.0
    v_fma_f32 v51, v55, v51, -1.0
    s_waitcnt lgkmcnt(3)
    v_mfma_f32_32x32x16_bf16 v[80:95], a[112:115], v[16:19], v[80:95]
    ds_read_b128 v[36:39], v2 offset:1024
    buffer_load_dwordx4 a[60:63], v2, s[36:39], s54 offen offset:3072 sc1
    s_add_u32 s54, s54, 4096
    v_rcp_f32 v51, v51
    v_fma_f32 v50, v78, v50, v78
    v_mfma_f32_32x32x16_bf16 v[80:95], a[116:119], v[20:23], v[80:95]
    ds_read_b128 v[16:19], v2 offset:2048
    buffer_load_dwordx4 a[64:67], v2, s[36:39], s54 offen offset:0 sc1
    v_fma_f32 v51, v79, v51, v79
    s_waitcnt lgkmcnt(3)
    v_mfma_f32_32x32x16_bf16 v[80:95], a[120:123], v[24:27], v[80:95]
    ds_read_b128 v[20:23], v2 offset:3072
    v_cvt_pk_bf16_f32 v63, v50, v51
    v_mfma_f32_32x32x16_bf16 v[80:95], a[124:127], v[28:31], v[80:95]
    ds_read_b128 v[24:27], v2 offset:4096
    buffer_load_dwordx4 a[68:71], v2, s[36:39], s54 offen offset:1024 sc1
    ds_write_b128 v13, v[60:63] offset:1024
    buffer_load_dwordx2 v[14:15], v11, s[12:15], 0 offen sc1
    v_lshl_add_u32 v10, s3, 12, v2
    v_lshl_add_u32 v9, v4, 2, s75
    s_waitcnt lgkmcnt(0)
    s_barrier
    v_mfma_f32_32x32x16_bf16 v[96:111], a[128:131], v[32:35], v[96:111]
    ds_read_b128 v[28:31], v2 offset:5120
    v_mfma_f32_32x32x16_bf16 v[96:111], a[132:135], v[36:39], v[96:111]
    ds_read_b128 v[32:35], v2 offset:6144
    buffer_load_dwordx4 a[72:75], v2, s[36:39], s54 offen offset:2048 sc1
    v_exp_f32 v52, v80
    v_mfma_f32_32x32x16_bf16 v[96:111], a[136:139], v[16:19], v[96:111]
    ds_read_b128 v[36:39], v2 offset:7168
    buffer_load_dwordx4 a[76:79], v2, s[36:39], s54 offen offset:3072 sc1
    s_add_u32 s54, s54, 4096
    v_exp_f32 v53, v81
    v_fma_f32 v48, v52, -0.5, -1.0
    v_fma_f32 v48, v52, v48, -1.0
    v_mfma_f32_32x32x16_bf16 v[96:111], a[140:143], v[20:23], v[96:111]
    ds_read_b128 v[16:19], v2 offset:8192
    v_rcp_f32 v48, v48
    s_waitcnt lgkmcnt(3)
    v_mfma_f32_32x32x16_bf16 v[96:111], a[144:147], v[24:27], v[96:111]
    ds_read_b128 v[20:23], v2 offset:9216
    buffer_load_dwordx4 a[80:83], v2, s[36:39], s54 offen offset:0 sc1
    v_exp_f32 v54, v82
    v_fma_f32 v49, v53, -0.5, -1.0
    v_fma_f32 v49, v53, v49, -1.0
    v_mfma_f32_32x32x16_bf16 v[96:111], a[148:151], v[28:31], v[96:111]
    ds_read_b128 v[24:27], v2 offset:10240
    buffer_load_dwordx4 a[84:87], v2, s[36:39], s54 offen offset:1024 sc1
    v_rcp_f32 v49, v49
    v_fma_f32 v48, v80, v48, v80
    s_waitcnt lgkmcnt(3)
    v_mfma_f32_32x32x16_bf16 v[96:111], a[152:155], v[32:35], v[96:111]
    ds_read_b128 v[28:31], v2 offset:11264
    v_exp_f32 v55, v83
    v_fma_f32 v50, v54, -0.5, -1.0
    v_fma_f32 v50, v54, v50, -1.0
    v_rcp_f32 v50, v50
    v_fma_f32 v49, v81, v49, v81
    v_mfma_f32_32x32x16_bf16 v[96:111], a[156:159], v[36:39], v[96:111]
    ds_read_b128 v[32:35], v2 offset:12288
    buffer_load_dwordx4 a[88:91], v2, s[36:39], s54 offen offset:2048 sc1
    v_exp_f32 v52, v84
    v_cvt_pk_bf16_f32 v56, v48, v49
    v_fma_f32 v51, v55, -0.5, -1.0
    v_fma_f32 v51, v55, v51, -1.0
    s_waitcnt lgkmcnt(3)
    v_mfma_f32_32x32x16_bf16 v[96:111], a[160:163], v[16:19], v[96:111]
    ds_read_b128 v[36:39], v2 offset:13312
    v_rcp_f32 v51, v51
    v_fma_f32 v50, v82, v50, v82
    v_mfma_f32_32x32x16_bf16 v[96:111], a[164:167], v[20:23], v[96:111]
    ds_read_b128 v[16:19], v2 offset:14336
    buffer_load_dwordx4 a[92:95], v2, s[36:39], s54 offen offset:3072 sc1
    s_add_u32 s54, s54, 4096
    v_exp_f32 v53, v85
    v_fma_f32 v48, v52, -0.5, -1.0
    v_fma_f32 v48, v52, v48, -1.0
    s_waitcnt lgkmcnt(3)
    v_mfma_f32_32x32x16_bf16 v[96:111], a[168:171], v[24:27], v[96:111]
    ds_read_b128 v[20:23], v2 offset:15360
    buffer_load_dwordx4 a[96:99], v2, s[36:39], s54 offen offset:0 sc1
    v_rcp_f32 v48, v48
    v_fma_f32 v51, v83, v51, v83
    v_mfma_f32_32x32x16_bf16 v[96:111], a[172:175], v[28:31], v[96:111]
    ds_read_b128 v[24:27], v2 offset:16384
    v_exp_f32 v54, v86
    v_cvt_pk_bf16_f32 v57, v50, v51
    v_fma_f32 v49, v53, -0.5, -1.0
    v_fma_f32 v49, v53, v49, -1.0
    v_rcp_f32 v49, v49
    v_fma_f32 v48, v84, v48, v84
    s_waitcnt lgkmcnt(3)
    v_mfma_f32_32x32x16_bf16 v[96:111], a[176:179], v[32:35], v[96:111]
    ds_read_b128 v[28:31], v2 offset:17408
    buffer_load_dwordx4 a[100:103], v2, s[36:39], s54 offen offset:1024 sc1
    v_exp_f32 v55, v87
    v_fma_f32 v50, v54, -0.5, -1.0
    v_fma_f32 v50, v54, v50, -1.0
    v_mfma_f32_32x32x16_bf16 v[96:111], a[180:183], v[36:39], v[96:111]
    ds_read_b128 v[32:35], v2 offset:18432
    buffer_load_dwordx4 a[104:107], v2, s[36:39], s54 offen offset:2048 sc1
    v_rcp_f32 v50, v50
    v_fma_f32 v49, v85, v49, v85
    s_waitcnt lgkmcnt(3)
    v_mfma_f32_32x32x16_bf16 v[96:111], a[184:187], v[16:19], v[96:111]
    ds_read_b128 v[36:39], v2 offset:19456
    v_exp_f32 v52, v88
    v_cvt_pk_bf16_f32 v58, v48, v49
    v_fma_f32 v51, v55, -0.5, -1.0
    v_fma_f32 v51, v55, v51, -1.0
    v_mfma_f32_32x32x16_bf16 v[96:111], a[188:191], v[20:23], v[96:111]
    ds_read_b128 v[16:19], v2 offset:20480
    buffer_load_dwordx4 a[108:111], v2, s[36:39], s54 offen offset:3072 sc1
    s_add_u32 s54, s54, 4096
    v_rcp_f32 v51, v51
    v_fma_f32 v50, v86, v50, v86
    s_waitcnt lgkmcnt(3)
    v_mfma_f32_32x32x16_bf16 v[96:111], a[192:195], v[24:27], v[96:111]
    ds_read_b128 v[20:23], v2 offset:21504
    v_exp_f32 v53, v89
    v_fma_f32 v48, v52, -0.5, -1.0
    v_fma_f32 v48, v52, v48, -1.0
    v_rcp_f32 v48, v48
    v_fma_f32 v51, v87, v51, v87
    v_mfma_f32_32x32x16_bf16 v[96:111], a[196:199], v[28:31], v[96:111]
    ds_read_b128 v[24:27], v2 offset:22528
    buffer_load_dwordx4 a[112:115], v2, s[36:39], s54 offen offset:0 sc1
    v_exp_f32 v54, v90
    v_cvt_pk_bf16_f32 v59, v50, v51
    v_fma_f32 v49, v53, -0.5, -1.0
    v_fma_f32 v49, v53, v49, -1.0
    s_waitcnt lgkmcnt(3)
    v_mfma_f32_32x32x16_bf16 v[96:111], a[200:203], v[32:35], v[96:111]
    ds_read_b128 v[28:31], v2 offset:23552
    buffer_load_dwordx4 a[116:119], v2, s[36:39], s54 offen offset:1024 sc1
    v_rcp_f32 v49, v49
    v_fma_f32 v48, v88, v48, v88
    ds_write_b128 v12, v[56:59] offset:0
    v_mfma_f32_32x32x16_bf16 v[96:111], a[204:207], v[36:39], v[96:111]
    ds_read_b128 v[32:35], v2 offset:24576
    v_exp_f32 v55, v91
    v_fma_f32 v50, v54, -0.5, -1.0
    v_fma_f32 v50, v54, v50, -1.0
    s_waitcnt lgkmcnt(4)
    v_mfma_f32_32x32x16_bf16 v[96:111], a[208:211], v[16:19], v[96:111]
    ds_read_b128 v[36:39], v2 offset:25600
    buffer_load_dwordx4 a[120:123], v2, s[36:39], s54 offen offset:2048 sc1
    v_rcp_f32 v50, v50
    v_fma_f32 v49, v89, v49, v89
    v_mfma_f32_32x32x16_bf16 v[96:111], a[212:215], v[20:23], v[96:111]
    ds_read_b128 v[16:19], v2 offset:26624
    buffer_load_dwordx4 a[124:127], v2, s[36:39], s54 offen offset:3072 sc1
    s_add_u32 s54, s54, 4096
    v_exp_f32 v52, v92
    v_cvt_pk_bf16_f32 v60, v48, v49
    v_fma_f32 v51, v55, -0.5, -1.0
    v_fma_f32 v51, v55, v51, -1.0
    v_rcp_f32 v51, v51
    v_fma_f32 v50, v90, v50, v90
    s_waitcnt lgkmcnt(4)
    v_mfma_f32_32x32x16_bf16 v[96:111], a[216:219], v[24:27], v[96:111]
    ds_read_b128 v[20:23], v2 offset:27648
    v_exp_f32 v53, v93
    v_fma_f32 v48, v52, -0.5, -1.0
    v_fma_f32 v48, v52, v48, -1.0
    v_mfma_f32_32x32x16_bf16 v[96:111], a[220:223], v[28:31], v[96:111]
    ds_read_b128 v[24:27], v2 offset:28672
    buffer_load_dwordx4 a[128:131], v2, s[36:39], s54 offen offset:0 sc1
    v_rcp_f32 v48, v48
    v_fma_f32 v51, v91, v51, v91
    s_waitcnt lgkmcnt(3)
    v_mfma_f32_32x32x16_bf16 v[96:111], a[224:227], v[32:35], v[96:111]
    ds_read_b128 v[28:31], v2 offset:29696
    v_exp_f32 v54, v94
    v_cvt_pk_bf16_f32 v61, v50, v51
    v_fma_f32 v49, v53, -0.5, -1.0
    v_fma_f32 v49, v53, v49, -1.0
    v_mfma_f32_32x32x16_bf16 v[96:111], a[228:231], v[36:39], v[96:111]
    ds_read_b128 v[32:35], v2 offset:30720
    buffer_load_dwordx4 a[132:135], v2, s[36:39], s54 offen offset:1024 sc1
    v_rcp_f32 v49, v49
    v_fma_f32 v48, v92, v48, v92
    s_waitcnt lgkmcnt(3)
    v_mfma_f32_32x32x16_bf16 v[96:111], a[232:235], v[16:19], v[96:111]
    ds_read_b128 v[36:39], v2 offset:31744
    buffer_load_dwordx4 a[136:139], v2, s[36:39], s55 offen offset:0 sc1
    v_exp_f32 v55, v95
    v_fma_f32 v50, v54, -0.5, -1.0
    v_fma_f32 v50, v54, v50, -1.0
    v_rcp_f32 v50, v50
    v_fma_f32 v49, v93, v49, v93
    v_mfma_f32_32x32x16_bf16 v[96:111], a[236:239], v[20:23], v[96:111]
    ds_read_b128 v[16:19], v7 offset:16384
    v_cvt_pk_bf16_f32 v62, v48, v49
    v_fma_f32 v51, v55, -0.5, -1.0
    v_fma_f32 v51, v55, v51, -1.0
    s_waitcnt lgkmcnt(3)
    v_mfma_f32_32x32x16_bf16 v[96:111], a[240:243], v[24:27], v[96:111]
    ds_read_b128 v[20:23], v7 offset:17408
    buffer_load_dwordx4 a[140:143], v2, s[36:39], s55 offen offset:1024 sc1
    v_rcp_f32 v51, v51
    v_fma_f32 v50, v94, v50, v94
    v_mfma_f32_32x32x16_bf16 v[96:111], a[244:247], v[28:31], v[96:111]
    ds_read_b128 v[24:27], v7 offset:18432
    buffer_load_dwordx4 a[144:147], v2, s[36:39], s55 offen offset:2048 sc1
    v_fma_f32 v51, v95, v51, v95
    s_waitcnt lgkmcnt(3)
    v_mfma_f32_32x32x16_bf16 v[96:111], a[248:251], v[32:35], v[96:111]
    ds_read_b128 v[28:31], v7 offset:19456
    v_cvt_pk_bf16_f32 v63, v50, v51
    v_mfma_f32_32x32x16_bf16 v[96:111], a[252:255], v[36:39], v[96:111]
    ds_read_b128 v[32:35], v7 offset:20480
    buffer_load_dwordx4 a[148:151], v2, s[36:39], s55 offen offset:3072 sc1
    s_add_u32 s55, s55, 4096
    ds_write_b128 v12, v[60:63] offset:1024
    s_waitcnt lgkmcnt(0)
    s_barrier
    v_mfma_f32_32x32x16_bf16 v[64:79], v[192:195], v[16:19], 0
    ds_read_b128 v[36:39], v7 offset:21504
    buffer_load_dwordx4 a[152:155], v2, s[36:39], s55 offen offset:0 sc1
    v_mfma_f32_32x32x16_bf16 v[80:95], v[196:199], v[16:19], 0
    s_nop 1
    v_exp_f32 v52, v96
    v_exp_f32 v53, v97
    v_fma_f32 v48, v52, -0.5, -1.0
    v_fma_f32 v48, v52, v48, -1.0
    v_mfma_f32_32x32x16_bf16 v[64:79], v[200:203], v[20:23], v[64:79]
    ds_read_b128 v[16:19], v7 offset:0
    buffer_load_dwordx4 a[156:159], v2, s[36:39], s55 offen offset:1024 sc1
    v_rcp_f32 v48, v48
    v_mfma_f32_32x32x16_bf16 v[80:95], v[204:207], v[20:23], v[80:95]
    buffer_load_dwordx4 a[160:163], v2, s[36:39], s55 offen offset:2048 sc1
    v_exp_f32 v54, v98
    v_fma_f32 v49, v53, -0.5, -1.0
    v_fma_f32 v49, v53, v49, -1.0
    v_rcp_f32 v49, v49
    v_fma_f32 v48, v96, v48, v96
    v_mfma_f32_32x32x16_bf16 v[64:79], v[208:211], v[24:27], v[64:79]
    ds_read_b128 v[20:23], v7 offset:1024
    buffer_load_dwordx4 a[164:167], v2, s[36:39], s55 offen offset:3072 sc1
    s_add_u32 s55, s55, 4096
    v_exp_f32 v55, v99
    v_fma_f32 v50, v54, -0.5, -1.0
    v_fma_f32 v50, v54, v50, -1.0
    v_mfma_f32_32x32x16_bf16 v[80:95], v[212:215], v[24:27], v[80:95]
    v_rcp_f32 v50, v50
    v_fma_f32 v49, v97, v49, v97
    v_mfma_f32_32x32x16_bf16 v[64:79], v[216:219], v[28:31], v[64:79]
    ds_read_b128 v[24:27], v7 offset:2048
    buffer_load_dwordx4 a[168:171], v2, s[36:39], s55 offen offset:0 sc1
    v_exp_f32 v52, v100
    v_cvt_pk_bf16_f32 v56, v48, v49
    v_fma_f32 v51, v55, -0.5, -1.0
    v_fma_f32 v51, v55, v51, -1.0
    v_rcp_f32 v51, v51
    v_fma_f32 v50, v98, v50, v98
    v_mfma_f32_32x32x16_bf16 v[80:95], v[220:223], v[28:31], v[80:95]
    buffer_load_dwordx4 a[172:175], v2, s[36:39], s55 offen offset:1024 sc1
    v_exp_f32 v53, v101
    v_fma_f32 v48, v52, -0.5, -1.0
    v_fma_f32 v48, v52, v48, -1.0
    s_waitcnt vmcnt(52) lgkmcnt(3)
    v_mfma_f32_32x32x16_bf16 v[64:79], v[224:227], v[32:35], v[64:79]
    ds_read_b128 v[28:31], v7 offset:3072
    buffer_load_dwordx4 a[176:179], v2, s[36:39], s55 offen offset:2048 sc1
    v_rcp_f32 v48, v48
    v_fma_f32 v51, v99, v51, v99
    v_exp_f32 v54, v102
    v_cvt_pk_bf16_f32 v57, v50, v51
    v_fma_f32 v49, v53, -0.5, -1.0
    v_fma_f32 v49, v53, v49, -1.0
    v_mfma_f32_32x32x16_bf16 v[80:95], v[228:231], v[32:35], v[80:95]
    buffer_load_dwordx4 a[180:183], v2, s[36:39], s55 offen offset:3072 sc1
    s_add_u32 s55, s55, 4096
    v_rcp_f32 v49, v49
    v_fma_f32 v48, v100, v48, v100
    v_mfma_f32_32x32x16_bf16 v[64:79], v[232:235], v[36:39], v[64:79]
    ds_read_b128 v[32:35], v7 offset:4096
    v_exp_f32 v55, v103
    v_fma_f32 v50, v54, -0.5, -1.0
    v_fma_f32 v50, v54, v50, -1.0
    v_mfma_f32_32x32x16_bf16 v[80:95], v[236:239], v[36:39], v[80:95]
    buffer_load_dwordx4 a[184:187], v2, s[36:39], s55 offen offset:0 sc1
    v_rcp_f32 v50, v50
    v_fma_f32 v49, v101, v49, v101
    v_exp_f32 v52, v104
    v_cvt_pk_bf16_f32 v58, v48, v49
    v_fma_f32 v51, v55, -0.5, -1.0
    v_fma_f32 v51, v55, v51, -1.0
    s_waitcnt vmcnt(51) lgkmcnt(3)
    v_mfma_f32_32x32x16_bf16 v[64:79], v[240:243], v[16:19], v[64:79]
    ds_read_b128 v[36:39], v7 offset:5120
    buffer_load_dwordx4 a[188:191], v2, s[36:39], s55 offen offset:1024 sc1
    v_rcp_f32 v51, v51
    v_fma_f32 v50, v102, v50, v102
    v_mfma_f32_32x32x16_bf16 v[80:95], v[244:247], v[16:19], v[80:95]
    buffer_load_dwordx4 a[192:195], v2, s[36:39], s55 offen offset:2048 sc1
    v_exp_f32 v53, v105
    v_fma_f32 v48, v52, -0.5, -1.0
    v_fma_f32 v48, v52, v48, -1.0
    v_mfma_f32_32x32x16_bf16 v[64:79], v[248:251], v[20:23], v[64:79]
    ds_read_b128 v[16:19], v7 offset:6144
    v_rcp_f32 v48, v48
    v_fma_f32 v51, v103, v51, v103
    v_exp_f32 v54, v106
    v_cvt_pk_bf16_f32 v59, v50, v51
    v_fma_f32 v49, v53, -0.5, -1.0
    v_fma_f32 v49, v53, v49, -1.0
    v_mfma_f32_32x32x16_bf16 v[80:95], v[252:255], v[20:23], v[80:95]
    buffer_load_dwordx4 a[196:199], v2, s[36:39], s55 offen offset:3072 sc1
    s_add_u32 s55, s55, 4096
    v_rcp_f32 v49, v49
    v_fma_f32 v48, v104, v48, v104
    ds_write_b128 v12, v[56:59] offset:8192
    s_waitcnt vmcnt(53) lgkmcnt(4)
    v_mfma_f32_32x32x16_bf16 v[64:79], v[128:131], v[24:27], v[64:79]
    ds_read_b128 v[20:23], v7 offset:7168
    buffer_load_dwordx4 a[200:203], v2, s[36:39], s55 offen offset:0 sc1
    v_exp_f32 v55, v107
    v_fma_f32 v50, v54, -0.5, -1.0
    v_fma_f32 v50, v54, v50, -1.0
    v_rcp_f32 v50, v50
    v_fma_f32 v49, v105, v49, v105
    v_mfma_f32_32x32x16_bf16 v[80:95], v[132:135], v[24:27], v[80:95]
    buffer_load_dwordx4 a[204:207], v2, s[36:39], s55 offen offset:1024 sc1
    v_exp_f32 v52, v108
    v_cvt_pk_bf16_f32 v60, v48, v49
    v_fma_f32 v51, v55, -0.5, -1.0
    v_fma_f32 v51, v55, v51, -1.0
    v_mfma_f32_32x32x16_bf16 v[64:79], v[136:139], v[28:31], v[64:79]
    v_rcp_f32 v51, v51
    v_fma_f32 v50, v106, v50, v106
    v_mfma_f32_32x32x16_bf16 v[80:95], v[140:143], v[28:31], v[80:95]
    buffer_load_dwordx4 a[208:211], v2, s[36:39], s55 offen offset:2048 sc1
    v_exp_f32 v53, v109
    v_fma_f32 v48, v52, -0.5, -1.0
    v_fma_f32 v48, v52, v48, -1.0
    v_rcp_f32 v48, v48
    v_fma_f32 v51, v107, v51, v107
    s_waitcnt lgkmcnt(3)
    v_mfma_f32_32x32x16_bf16 v[64:79], v[144:147], v[32:35], v[64:79]
    buffer_load_dwordx4 a[212:215], v2, s[36:39], s55 offen offset:3072 sc1
    s_add_u32 s55, s55, 4096
    v_exp_f32 v54, v110
    v_cvt_pk_bf16_f32 v61, v50, v51
    v_fma_f32 v49, v53, -0.5, -1.0
    v_fma_f32 v49, v53, v49, -1.0
    v_mfma_f32_32x32x16_bf16 v[80:95], v[148:151], v[32:35], v[80:95]
    buffer_load_dwordx4 a[216:219], v2, s[36:39], s55 offen offset:0 sc1
    v_rcp_f32 v49, v49
    v_fma_f32 v48, v108, v48, v108
    v_exp_f32 v55, v111
    v_fma_f32 v50, v54, -0.5, -1.0
    v_fma_f32 v50, v54, v50, -1.0
    v_mfma_f32_32x32x16_bf16 v[64:79], v[152:155], v[36:39], v[64:79]
    buffer_load_dwordx4 a[220:223], v2, s[36:39], s55 offen offset:1024 sc1
    v_rcp_f32 v50, v50
    v_fma_f32 v49, v109, v49, v109
    v_mfma_f32_32x32x16_bf16 v[80:95], v[156:159], v[36:39], v[80:95]
    v_cvt_pk_bf16_f32 v62, v48, v49
    v_fma_f32 v51, v55, -0.5, -1.0
    v_fma_f32 v51, v55, v51, -1.0
    s_waitcnt lgkmcnt(0)
    v_mfma_f32_32x32x16_bf16 v[64:79], v[160:163], v[16:19], v[64:79]
    v_rcp_f32 v51, v51
    v_fma_f32 v50, v110, v50, v110
    v_fma_f32 v51, v111, v51, v111
    v_mfma_f32_32x32x16_bf16 v[80:95], v[164:167], v[16:19], v[80:95]
    v_cvt_pk_bf16_f32 v63, v50, v51
    v_mfma_f32_32x32x16_bf16 v[64:79], v[168:171], v[20:23], v[64:79]
    ds_write_b128 v12, v[60:63] offset:9216
    v_mfma_f32_32x32x16_bf16 v[80:95], v[172:175], v[20:23], v[80:95]
    s_waitcnt vmcnt(38)
    v_cmp_ne_u32 vcc, s94, v14
    s_nop 1
    s_cbranch_vccnz L_rdy
L_rdy_back:
    s_xor_b32 s22, s20, 1
    v_readlane_b32 s22, v15, s22
    s_nop 1
    s_cmp_eq_u32 s22, s29
    s_cselect_b32 s23, s50, 2147483392
    s_cselect_b32 s50, 2147483392, s50
    s_waitcnt lgkmcnt(0)
    s_barrier
    ds_read_b128 v[24:27], v7 offset:8192
    ds_read_b128 v[28:31], v7 offset:9216
    ds_read_b128 v[32:35], v7 offset:10240
    ds_read_b128 v[36:39], v7 offset:11264
    ds_read_b128 v[16:19], v7 offset:12288
    s_waitcnt lgkmcnt(3)
    v_mfma_f32_32x32x16_bf16 v[64:79], v[176:179], v[24:27], v[64:79]
    ds_read_b128 v[20:23], v7 offset:13312
    v_mfma_f32_32x32x16_bf16 v[64:79], v[180:183], v[28:31], v[64:79]
    ds_read_b128 v[24:27], v7 offset:14336
    s_waitcnt lgkmcnt(3)
    v_mfma_f32_32x32x16_bf16 v[64:79], v[184:187], v[32:35], v[64:79]
    ds_read_b128 v[28:31], v7 offset:15360
    v_mfma_f32_32x32x16_bf16 v[64:79], v[188:191], v[36:39], v[64:79]
    ds_read_b128 v[32:35], v7 offset:8192
    s_waitcnt lgkmcnt(3)
    v_mfma_f32_32x32x16_bf16 v[64:79], a[0:3], v[16:19], v[64:79]
    ds_read_b128 v[36:39], v7 offset:9216
    v_mfma_f32_32x32x16_bf16 v[64:79], a[4:7], v[20:23], v[64:79]
    ds_read_b128 v[16:19], v7 offset:10240
    s_waitcnt lgkmcnt(3)
    v_mfma_f32_32x32x16_bf16 v[64:79], a[8:11], v[24:27], v[64:79]
    ds_read_b128 v[20:23], v7 offset:11264
    v_mfma_f32_32x32x16_bf16 v[64:79], a[12:15], v[28:31], v[64:79]
    ds_read_b128 v[24:27], v7 offset:12288
    s_waitcnt lgkmcnt(3)
    v_mfma_f32_32x32x16_bf16 v[80:95], a[16:19], v[32:35], v[80:95]
    ds_read_b128 v[28:31], v7 offset:13312
    v_mfma_f32_32x32x16_bf16 v[80:95], a[20:23], v[36:39], v[80:95]
    ds_read_b128 v[32:35], v7 offset:14336
    s_nop 5
    v_cvt_pk_bf16_f32 v56, v64, v68
    v_cvt_pk_bf16_f32 v57, v72, v76
    s_waitcnt lgkmcnt(3)
    v_mfma_f32_32x32x16_bf16 v[80:95], a[24:27], v[16:19], v[80:95]
    ds_read_b128 v[36:39], v7 offset:15360
    v_cvt_pk_bf16_f32 v58, v65, v69
    v_cvt_pk_bf16_f32 v59, v73, v77
    v_mfma_f32_32x32x16_bf16 v[80:95], a[28:31], v[20:23], v[80:95]
    ds_read_b128 v[16:19], v7 offset:16384
    buffer_store_dwordx4 v[56:59], v2, s[12:15], s48 offen offset:0 sc1
    v_cvt_pk_bf16_f32 v60, v66, v70
    s_waitcnt lgkmcnt(3)
    v_mfma_f32_32x32x16_bf16 v[80:95], a[32:35], v[24:27], v[80:95]
    ds_read_b128 v[20:23], v7 offset:17408
    v_cvt_pk_bf16_f32 v61, v74, v78
    v_cvt_pk_bf16_f32 v62, v67, v71
    v_mfma_f32_32x32x16_bf16 v[80:95], a[36:39], v[28:31], v[80:95]
    ds_read_b128 v[24:27], v7 offset:18432
    v_cvt_pk_bf16_f32 v63, v75, v79
    buffer_store_dwordx4 v[60:63], v2, s[12:15], s48 offen offset:1024 sc1
    s_waitcnt lgkmcnt(3)
    v_mfma_f32_32x32x16_bf16 v[80:95], a[40:43], v[32:35], v[80:95]
    ds_read_b128 v[28:31], v7 offset:19456
    v_mfma_f32_32x32x16_bf16 v[80:95], a[44:47], v[36:39], v[80:95]
    ds_read_b128 v[32:35], v7 offset:20480
    s_waitcnt lgkmcnt(3)
    v_mfma_f32_32x32x16_bf16 v[96:111], a[48:51], v[16:19], 0
    ds_read_b128 v[36:39], v7 offset:21504
    v_mfma_f32_32x32x16_bf16 v[96:111], a[52:55], v[20:23], v[96:111]
    ds_read_b128 v[16:19], v7 offset:0
    s_nop 5
    v_cvt_pk_bf16_f32 v56, v80, v84
    v_cvt_pk_bf16_f32 v57, v88, v92
    s_waitcnt lgkmcnt(3)
    v_mfma_f32_32x32x16_bf16 v[96:111], a[56:59], v[24:27], v[96:111]
    ds_read_b128 v[20:23], v7 offset:1024
    v_cvt_pk_bf16_f32 v58, v81, v85
    v_cvt_pk_bf16_f32 v59, v89, v93
    v_mfma_f32_32x32x16_bf16 v[96:111], a[60:63], v[28:31], v[96:111]
    ds_read_b128 v[24:27], v7 offset:2048
    buffer_store_dwordx4 v[56:59], v2, s[12:15], s49 offen offset:0 sc1
    v_cvt_pk_bf16_f32 v60, v82, v86
    s_waitcnt lgkmcnt(3)
    v_mfma_f32_32x32x16_bf16 v[96:111], a[64:67], v[32:35], v[96:111]
    ds_read_b128 v[28:31], v7 offset:3072
    v_cvt_pk_bf16_f32 v61, v90, v94
    v_cvt_pk_bf16_f32 v62, v83, v87
    v_mfma_f32_32x32x16_bf16 v[96:111], a[68:71], v[36:39], v[96:111]
    ds_read_b128 v[32:35], v7 offset:4096
    v_cvt_pk_bf16_f32 v63, v91, v95
    buffer_store_dwordx4 v[60:63], v2, s[12:15], s49 offen offset:1024 sc1
    s_waitcnt vmcnt(40) lgkmcnt(3)
    v_mfma_f32_32x32x16_bf16 v[96:111], a[72:75], v[16:19], v[96:111]
    ds_read_b128 v[36:39], v7 offset:5120
    v_mfma_f32_32x32x16_bf16 v[96:111], a[76:79], v[20:23], v[96:111]
    ds_read_b128 v[16:19], v7 offset:6144
    s_waitcnt vmcnt(38) lgkmcnt(3)
    v_mfma_f32_32x32x16_bf16 v[96:111], a[80:83], v[24:27], v[96:111]
    ds_read_b128 v[20:23], v7 offset:7168
    ds_read_b128 v[112:115], v10 offset:35840
    ds_read_b128 v[116:119], v10 offset:36864
    v_mfma_f32_32x32x16_bf16 v[96:111], a[84:87], v[28:31], v[96:111]
    ds_read_b128 v[24:27], v7 offset:8192
    ds_read_b128 v[120:123], v10 offset:37888
    ds_read_b128 v[124:127], v10 offset:38912
    s_waitcnt vmcnt(36) lgkmcnt(7)
    v_mfma_f32_32x32x16_bf16 v[96:111], a[88:91], v[32:35], v[96:111]
    ds_read_b128 v[28:31], v7 offset:9216
    ds_read_b32 v128, v9 offset:0
    v_mfma_f32_32x32x16_bf16 v[96:111], a[92:95], v[36:39], v[96:111]
    ds_read_b128 v[32:35], v7 offset:10240
    ds_read_b32 v129, v9 offset:128
    ds_read_b32 v130, v9 offset:256
    s_waitcnt vmcnt(34) lgkmcnt(10)
    v_mfma_f32_32x32x16_bf16 v[96:111], a[96:99], v[16:19], v[96:111]
    ds_read_b128 v[36:39], v7 offset:11264
    ds_read_b32 v131, v9 offset:384
    ds_read_b32 v132, v9 offset:528
    v_mfma_f32_32x32x16_bf16 v[96:111], a[100:103], v[20:23], v[96:111]
    ds_read_b128 v[16:19], v7 offset:12288
    ds_read_b32 v133, v9 offset:656
    s_waitcnt vmcnt(32) lgkmcnt(9)
    v_mfma_f32_32x32x16_bf16 v[96:111], a[104:107], v[24:27], v[96:111]
    ds_read_b128 v[20:23], v7 offset:13312
    ds_read_b32 v134, v9 offset:784
    ds_read_b32 v135, v9 offset:912
    v_mfma_f32_32x32x16_bf16 v[96:111], a[108:111], v[28:31], v[96:111]
    ds_read_b128 v[24:27], v7 offset:14336
    ds_read_b32 v136, v9 offset:1056
    ds_read_b32 v137, v9 offset:1184
    s_waitcnt vmcnt(30) lgkmcnt(10)
    v_mfma_f32_32x32x16_bf16 v[96:111], a[112:115], v[32:35], v[96:111]
    ds_read_b128 v[28:31], v7 offset:15360
    ds_read_b32 v138, v9 offset:1312
    v_mfma_f32_32x32x16_bf16 v[96:111], a[116:119], v[36:39], v[96:111]
    ds_read_b128 v[32:35], v7 offset:16384
    ds_read_b32 v139, v9 offset:1440
    ds_read_b32 v140, v9 offset:1584
    s_waitcnt vmcnt(28) lgkmcnt(10)
    v_mfma_f32_32x32x16_bf16 v[96:111], a[120:123], v[16:19], v[96:111]
    ds_read_b128 v[36:39], v7 offset:17408
    ds_read_b32 v141, v9 offset:1712
    ds_read_b32 v142, v9 offset:1840
    v_mfma_f32_32x32x16_bf16 v[96:111], a[124:127], v[20:23], v[96:111]
    ds_read_b128 v[16:19], v7 offset:18432
    ds_read_b32 v143, v9 offset:1968
    s_waitcnt vmcnt(26) lgkmcnt(9)
    v_mfma_f32_32x32x16_bf16 v[96:111], a[128:131], v[24:27], v[96:111]
    ds_read_b128 v[20:23], v7 offset:19456
    v_lshlrev_b32 v10, 16, v3
    v_mfma_f32_32x32x16_bf16 v[96:111], a[132:135], v[28:31], v[96:111]
    ds_read_b128 v[24:27], v7 offset:20480
    v_lshl_add_u32 v10, v4, 5, v10
    s_waitcnt vmcnt(24) lgkmcnt(6)
    v_mfma_f32_32x32x16_bf16 v[192:207], a[136:139], v[32:35], 0
    ds_read_b128 v[28:31], v7 offset:21504
    v_mfma_f32_32x32x16_bf16 v[192:207], a[140:143], v[36:39], v[192:207]
    ds_read_b128 v[32:35], v7 offset:0
    s_nop 4
    v_cvt_pk_bf16_f32 v56, v96, v100
    v_cvt_pk_bf16_f32 v57, v104, v108
    v_cvt_pk_bf16_f32 v58, v97, v101
    s_waitcnt vmcnt(22) lgkmcnt(3)
    v_mfma_f32_32x32x16_bf16 v[192:207], a[144:147], v[16:19], v[192:207]
    ds_read_b128 v[36:39], v7 offset:1024
    v_cvt_pk_bf16_f32 v59, v105, v109
    buffer_store_dwordx4 v[56:59], v2, s[12:15], s23 offen offset:0
    v_mfma_f32_32x32x16_bf16 v[192:207], a[148:151], v[20:23], v[192:207]
    ds_read_b128 v[16:19], v7 offset:2048
    buffer_store_dwordx4 v[56:59], v2, s[12:15], s50 offen offset:0 sc1
    v_cvt_pk_bf16_f32 v60, v98, v102
    v_cvt_pk_bf16_f32 v61, v106, v110
    s_waitcnt vmcnt(22) lgkmcnt(3)
    v_mfma_f32_32x32x16_bf16 v[192:207], a[152:155], v[24:27], v[192:207]
    ds_read_b128 v[20:23], v7 offset:3072
    v_cvt_pk_bf16_f32 v62, v99, v103
    v_cvt_pk_bf16_f32 v63, v107, v111
    buffer_load_dwordx4 v[208:211], v2, s[12:15], s24 offen offset:0 sc1
    buffer_load_dwordx4 v[212:215], v2, s[12:15], s24 offen offset:1024 sc1
    v_mfma_f32_32x32x16_bf16 v[192:207], a[156:159], v[28:31], v[192:207]
    ds_read_b128 v[24:27], v7 offset:4096
    buffer_store_dwordx4 v[60:63], v2, s[12:15], s23 offen offset:1024
    buffer_store_dwordx4 v[60:63], v2, s[12:15], s50 offen offset:1024 sc1
    s_waitcnt vmcnt(24) lgkmcnt(3)
    v_mfma_f32_32x32x16_bf16 v[192:207], a[160:163], v[32:35], v[192:207]
    ds_read_b128 v[28:31], v7 offset:5120
    v_mfma_f32_32x32x16_bf16 v[192:207], a[164:167], v[36:39], v[192:207]
    ds_read_b128 v[32:35], v7 offset:6144
    s_waitcnt vmcnt(22) lgkmcnt(3)
    v_mfma_f32_32x32x16_bf16 v[192:207], a[168:171], v[16:19], v[192:207]
    ds_read_b128 v[36:39], v7 offset:7168
    v_mfma_f32_32x32x16_bf16 v[192:207], a[172:175], v[20:23], v[192:207]
    ds_read_b128 v[16:19], v7 offset:8192
    s_waitcnt vmcnt(20) lgkmcnt(3)
    v_mfma_f32_32x32x16_bf16 v[192:207], a[176:179], v[24:27], v[192:207]
    ds_read_b128 v[20:23], v7 offset:9216
    v_mfma_f32_32x32x16_bf16 v[192:207], a[180:183], v[28:31], v[192:207]
    ds_read_b128 v[24:27], v7 offset:10240
    s_waitcnt vmcnt(18) lgkmcnt(3)
    v_mfma_f32_32x32x16_bf16 v[192:207], a[184:187], v[32:35], v[192:207]
    ds_read_b128 v[28:31], v7 offset:11264
    v_mfma_f32_32x32x16_bf16 v[192:207], a[188:191], v[36:39], v[192:207]
    ds_read_b128 v[32:35], v7 offset:12288
    s_waitcnt vmcnt(16) lgkmcnt(3)
    v_mfma_f32_32x32x16_bf16 v[192:207], a[192:195], v[16:19], v[192:207]
    ds_read_b128 v[36:39], v7 offset:13312
    buffer_load_dwordx4 v[216:219], v2, s[12:15], s25 offen offset:0 sc1
    buffer_load_dwordx4 v[220:223], v2, s[12:15], s25 offen offset:1024 sc1
    v_mfma_f32_32x32x16_bf16 v[192:207], a[196:199], v[20:23], v[192:207]
    ds_read_b128 v[16:19], v7 offset:14336
    s_waitcnt vmcnt(16) lgkmcnt(3)
    v_mfma_f32_32x32x16_bf16 v[192:207], a[200:203], v[24:27], v[192:207]
    ds_read_b128 v[20:23], v7 offset:15360
    v_mfma_f32_32x32x16_bf16 v[192:207], a[204:207], v[28:31], v[192:207]
    s_waitcnt vmcnt(14) lgkmcnt(2)
    v_mfma_f32_32x32x16_bf16 v[192:207], a[208:211], v[32:35], v[192:207]
    v_mfma_f32_32x32x16_bf16 v[192:207], a[212:215], v[36:39], v[192:207]
    s_waitcnt vmcnt(12) lgkmcnt(0)
    v_mfma_f32_32x32x16_bf16 v[192:207], a[216:219], v[16:19], v[192:207]
    v_mfma_f32_32x32x16_bf16 v[192:207], a[220:223], v[20:23], v[192:207]
    s_nop 11
    v_fmac_f32 v112, v192, v128
    v_fmac_f32 v113, v196, v129
    v_fmac_f32 v114, v200, v130
    v_fmac_f32 v115, v204, v131
    v_fmac_f32 v116, v193, v132
    v_fmac_f32 v117, v197, v133
    v_fmac_f32 v118, v201, v134
    v_fmac_f32 v119, v205, v135
    v_fmac_f32 v120, v194, v136
    v_fmac_f32 v121, v198, v137
    v_fmac_f32 v122, v202, v138
    v_fmac_f32 v123, v206, v139
    v_fmac_f32 v124, v195, v140
    v_fmac_f32 v125, v199, v141
    v_fmac_f32 v126, v203, v142
    v_fmac_f32 v127, v207, v143
    buffer_load_dwordx4 v[224:227], v2, s[12:15], s26 offen offset:0 sc1
    buffer_load_dwordx4 v[228:231], v2, s[12:15], s26 offen offset:1024 sc1
    s_waitcnt vmcnt(7)
    v_max3_u32 v8, v208, v209, v210
    s_waitcnt vmcnt(6)
    v_max3_u32 v8, v8, v211, v212
    v_max3_u32 v8, v8, v213, v214
    v_max_u32 v8, v8, v215
    v_cmp_eq_u32 vcc, -1, v8
    s_nop 1
    s_cbranch_vccnz L_in0
L_in0_back:
    v_lshlrev_b32 v48, 16, v208
    v_and_b32 v49, 0xffff0000, v208
    v_fmac_f32 v112, v48, v128
    v_fmac_f32 v113, v49, v129
    v_lshlrev_b32 v50, 16, v209
    v_and_b32 v51, 0xffff0000, v209
    v_fmac_f32 v114, v50, v130
    v_fmac_f32 v115, v51, v131
    v_lshlrev_b32 v52, 16, v210
    v_and_b32 v53, 0xffff0000, v210
    v_fmac_f32 v116, v52, v132
    v_fmac_f32 v117, v53, v133
    v_lshlrev_b32 v54, 16, v211
    v_and_b32 v55, 0xffff0000, v211
    v_fmac_f32 v118, v54, v134
    v_fmac_f32 v119, v55, v135
    v_lshlrev_b32 v48, 16, v212
    v_and_b32 v49, 0xffff0000, v212
    v_fmac_f32 v120, v48, v136
    v_fmac_f32 v121, v49, v137
    v_lshlrev_b32 v50, 16, v213
    v_and_b32 v51, 0xffff0000, v213
    v_fmac_f32 v122, v50, v138
    v_fmac_f32 v123, v51, v139
    v_lshlrev_b32 v52, 16, v214
    v_and_b32 v53, 0xffff0000, v214
    v_fmac_f32 v124, v52, v140
    v_fmac_f32 v125, v53, v141
    v_lshlrev_b32 v54, 16, v215
    v_and_b32 v55, 0xffff0000, v215
    v_fmac_f32 v126, v54, v142
    v_fmac_f32 v127, v55, v143
    s_waitcnt vmcnt(3)
    v_max3_u32 v8, v216, v217, v218
    s_waitcnt vmcnt(2)
    v_max3_u32 v8, v8, v219, v220
    v_max3_u32 v8, v8, v221, v222
    v_max_u32 v8, v8, v223
    v_cmp_eq_u32 vcc, -1, v8
    s_nop 1
    s_cbranch_vccnz L_in1
L_in1_back:
    v_lshlrev_b32 v48, 16, v216
    v_and_b32 v49, 0xffff0000, v216
    v_fmac_f32 v112, v48, v128
    v_fmac_f32 v113, v49, v129
    v_lshlrev_b32 v50, 16, v217
    v_and_b32 v51, 0xffff0000, v217
    v_fmac_f32 v114, v50, v130
    v_fmac_f32 v115, v51, v131
    v_lshlrev_b32 v52, 16, v218
    v_and_b32 v53, 0xffff0000, v218
    v_fmac_f32 v116, v52, v132
    v_fmac_f32 v117, v53, v133
    v_lshlrev_b32 v54, 16, v219
    v_and_b32 v55, 0xffff0000, v219
    v_fmac_f32 v118, v54, v134
    v_fmac_f32 v119, v55, v135
    v_lshlrev_b32 v48, 16, v220
    v_and_b32 v49, 0xffff0000, v220
    v_fmac_f32 v120, v48, v136
    v_fmac_f32 v121, v49, v137
    v_lshlrev_b32 v50, 16, v221
    v_and_b32 v51, 0xffff0000, v221
    v_fmac_f32 v122, v50, v138
    v_fmac_f32 v123, v51, v139
    v_lshlrev_b32 v52, 16, v222
    v_and_b32 v53, 0xffff0000, v222
    v_fmac_f32 v124, v52, v140
    v_fmac_f32 v125, v53, v141
    v_lshlrev_b32 v54, 16, v223
    v_and_b32 v55, 0xffff0000, v223
    v_fmac_f32 v126, v54, v142
    v_fmac_f32 v127, v55, v143
    s_waitcnt vmcnt(1)
    v_max3_u32 v8, v224, v225, v226
    s_waitcnt vmcnt(0)
    v_max3_u32 v8, v8, v227, v228
    v_max3_u32 v8, v8, v229, v230
    v_max_u32 v8, v8, v231
    v_cmp_eq_u32 vcc, -1, v8
    s_nop 1
    s_cbranch_vccnz L_in2
L_in2_back:
    v_lshlrev_b32 v48, 16, v224
    v_and_b32 v49, 0xffff0000, v224
    v_fmac_f32 v112, v48, v128
    v_fmac_f32 v113, v49, v129
    v_lshlrev_b32 v50, 16, v225
    v_and_b32 v51, 0xffff0000, v225
    v_fmac_f32 v114, v50, v130
    v_fmac_f32 v115, v51, v131
    v_lshlrev_b32 v52, 16, v226
    v_and_b32 v53, 0xffff0000, v226
    v_fmac_f32 v116, v52, v132
    v_fmac_f32 v117, v53, v133
    v_lshlrev_b32 v54, 16, v227
    v_and_b32 v55, 0xffff0000, v227
    v_fmac_f32 v118, v54, v134
    v_fmac_f32 v119, v55, v135
    v_lshlrev_b32 v48, 16, v228
    v_and_b32 v49, 0xffff0000, v228
    v_fmac_f32 v120, v48, v136
    v_fmac_f32 v121, v49, v137
    v_lshlrev_b32 v50, 16, v229
    v_and_b32 v51, 0xffff0000, v229
    v_fmac_f32 v122, v50, v138
    v_fmac_f32 v123, v51, v139
    v_lshlrev_b32 v52, 16, v230
    v_and_b32 v53, 0xffff0000, v230
    v_fmac_f32 v124, v52, v140
    v_fmac_f32 v125, v53, v141
    v_lshlrev_b32 v54, 16, v231
    v_and_b32 v55, 0xffff0000, v231
    v_fmac_f32 v126, v54, v142
    v_fmac_f32 v127, v55, v143
    v_cvt_pk_bf16_f32 v16, v112, v113
    v_cvt_pk_bf16_f32 v17, v114, v115
    v_cvt_pk_bf16_f32 v18, v116, v117
    v_cvt_pk_bf16_f32 v19, v118, v119
    buffer_store_dwordx4 v[16:19], v10, s[4:7], s76 offen offset:0
    v_cvt_pk_bf16_f32 v20, v120, v121
    v_cvt_pk_bf16_f32 v21, v122, v123
    v_cvt_pk_bf16_f32 v22, v124, v125
    v_cvt_pk_bf16_f32 v23, v126, v127
    buffer_store_dwordx4 v[20:23], v10, s[4:7], s76 offen offset:16
L_end_adaLN_cond__spectral_gfnet__dense_activation_mish__prompt_kernel:
L_exit_adaLN_cond__spectral_gfnet__dense_activation_mish__prompt_kernel:
    s_endpgm
L_a1:
    s_and_b32 s31, s2, 3
    s_mul_i32 s26, s31, 786432
    s_lshr_b32 s27, s2, 2
    s_lshl_b32 s27, s27, 7
    s_add_u32 s26, s26, s27
    s_mov_b32 s8, s72
    s_mov_b32 s9, s73
    s_mov_b32 s10, 0x300000
    s_mov_b32 s11, 0x20000
    v_lshl_add_u32 v7, s3, 6, v0
    v_lshrrev_b32 v8, 3, v7
    v_and_b32 v9, 7, v0
    v_mul_u32_u24 v11, 6144, v8
    v_lshl_add_u32 v11, v9, 4, v11
    buffer_load_dwordx4 v[24:27], v11, s[8:11], s26 offen nt
    s_add_u32 s26, s26, 196608
    buffer_load_dwordx4 v[28:31], v11, s[8:11], s26 offen nt
    s_add_u32 s26, s26, 196608
    buffer_load_dwordx4 v[32:35], v11, s[8:11], s26 offen nt
    s_add_u32 s26, s26, 196608
    buffer_load_dwordx4 v[36:39], v11, s[8:11], s26 offen nt
    v_lshrrev_b32 v56, 4, v7
    v_lshlrev_b32 v56, 8, v56
    v_lshl_add_u32 v56, v9, 5, v56
    v_lshlrev_b32 v57, 2, v0
    s_branch L_a1_back
L_a2:
    v_lshlrev_b32 v68, 16, v24
    v_and_b32 v69, 0xffff0000, v24
    v_lshlrev_b32 v70, 16, v25
    v_and_b32 v71, 0xffff0000, v25
    v_lshlrev_b32 v72, 16, v26
    v_and_b32 v73, 0xffff0000, v26
    v_lshlrev_b32 v74, 16, v27
    v_and_b32 v75, 0xffff0000, v27
    v_pk_mul_f32 v[60:61], v[68:69], v[108:109] op_sel:[0,0] op_sel_hi:[1,0]
    v_pk_mul_f32 v[62:63], v[70:71], v[108:109] op_sel:[0,0] op_sel_hi:[1,0]
    v_pk_mul_f32 v[64:65], v[72:73], v[108:109] op_sel:[0,0] op_sel_hi:[1,0]
    v_pk_mul_f32 v[66:67], v[74:75], v[108:109] op_sel:[0,0] op_sel_hi:[1,0]
    v_lshlrev_b32 v68, 16, v28
    v_and_b32 v69, 0xffff0000, v28
    v_lshlrev_b32 v70, 16, v29
    v_and_b32 v71, 0xffff0000, v29
    v_lshlrev_b32 v72, 16, v30
    v_and_b32 v73, 0xffff0000, v30
    v_lshlrev_b32 v74, 16, v31
    v_and_b32 v75, 0xffff0000, v31
    v_pk_fma_f32 v[60:61], v[68:69], v[108:109], v[60:61] op_sel:[0,1,0] op_sel_hi:[1,1,1]
    v_pk_fma_f32 v[62:63], v[70:71], v[108:109], v[62:63] op_sel:[0,1,0] op_sel_hi:[1,1,1]
    v_pk_fma_f32 v[64:65], v[72:73], v[108:109], v[64:65] op_sel:[0,1,0] op_sel_hi:[1,1,1]
    v_pk_fma_f32 v[66:67], v[74:75], v[108:109], v[66:67] op_sel:[0,1,0] op_sel_hi:[1,1,1]
    v_lshlrev_b32 v68, 16, v32
    v_and_b32 v69, 0xffff0000, v32
    v_lshlrev_b32 v70, 16, v33
    v_and_b32 v71, 0xffff0000, v33
    v_lshlrev_b32 v72, 16, v34
    v_and_b32 v73, 0xffff0000, v34
    v_lshlrev_b32 v74, 16, v35
    v_and_b32 v75, 0xffff0000, v35
    v_pk_fma_f32 v[60:61], v[68:69], v[110:111], v[60:61] op_sel:[0,0,0] op_sel_hi:[1,0,1]
    v_pk_fma_f32 v[62:63], v[70:71], v[110:111], v[62:63] op_sel:[0,0,0] op_sel_hi:[1,0,1]
    v_pk_fma_f32 v[64:65], v[72:73], v[110:111], v[64:65] op_sel:[0,0,0] op_sel_hi:[1,0,1]
    v_pk_fma_f32 v[66:67], v[74:75], v[110:111], v[66:67] op_sel:[0,0,0] op_sel_hi:[1,0,1]
    v_lshlrev_b32 v68, 16, v36
    v_and_b32 v69, 0xffff0000, v36
    v_lshlrev_b32 v70, 16, v37
    v_and_b32 v71, 0xffff0000, v37
    v_lshlrev_b32 v72, 16, v38
    v_and_b32 v73, 0xffff0000, v38
    v_lshlrev_b32 v74, 16, v39
    v_and_b32 v75, 0xffff0000, v39
    v_pk_fma_f32 v[60:61], v[68:69], v[110:111], v[60:61] op_sel:[0,1,0] op_sel_hi:[1,1,1]
    v_pk_fma_f32 v[62:63], v[70:71], v[110:111], v[62:63] op_sel:[0,1,0] op_sel_hi:[1,1,1]
    v_pk_fma_f32 v[64:65], v[72:73], v[110:111], v[64:65] op_sel:[0,1,0] op_sel_hi:[1,1,1]
    v_pk_fma_f32 v[66:67], v[74:75], v[110:111], v[66:67] op_sel:[0,1,0] op_sel_hi:[1,1,1]
    v_add_f32_dpp v60, v60, v60 row_ror:8 row_mask:0xf bank_mask:0xf
    v_add_f32_dpp v61, v61, v61 row_ror:8 row_mask:0xf bank_mask:0xf
    v_add_f32_dpp v62, v62, v62 row_ror:8 row_mask:0xf bank_mask:0xf
    v_add_f32_dpp v63, v63, v63 row_ror:8 row_mask:0xf bank_mask:0xf
    v_add_f32_dpp v64, v64, v64 row_ror:8 row_mask:0xf bank_mask:0xf
    v_add_f32_dpp v65, v65, v65 row_ror:8 row_mask:0xf bank_mask:0xf
    v_add_f32_dpp v66, v66, v66 row_ror:8 row_mask:0xf bank_mask:0xf
    v_add_f32_dpp v67, v67, v67 row_ror:8 row_mask:0xf bank_mask:0xf
    ds_write_b128 v56, v[60:63] offset:44032
    ds_write_b128 v56, v[64:67] offset:44048
    s_waitcnt lgkmcnt(0)
    s_barrier
    s_cmp_lg_u32 s3, 0
    s_cbranch_scc1 L_a2_back
    ds_read_b32 v60, v57 offset:44032
    ds_read_b32 v61, v57 offset:44288
    ds_read_b32 v62, v57 offset:44544
    ds_read_b32 v63, v57 offset:44800
    ds_read_b32 v64, v57 offset:45056
    ds_read_b32 v65, v57 offset:45312
    ds_read_b32 v66, v57 offset:45568
    ds_read_b32 v67, v57 offset:45824
    ds_read_b32 v68, v57 offset:46080
    ds_read_b32 v69, v57 offset:46336
    ds_read_b32 v70, v57 offset:46592
    ds_read_b32 v71, v57 offset:46848
    ds_read_b32 v72, v57 offset:47104
    ds_read_b32 v73, v57 offset:47360
    ds_read_b32 v74, v57 offset:47616
    ds_read_b32 v75, v57 offset:47872
    s_waitcnt lgkmcnt(0)
    v_pk_add_f32 v[60:61], v[60:61], v[68:69]
    v_pk_add_f32 v[62:63], v[62:63], v[70:71]
    v_pk_add_f32 v[64:65], v[64:65], v[72:73]
    v_pk_add_f32 v[66:67], v[66:67], v[74:75]
    v_pk_add_f32 v[60:61], v[60:61], v[64:65]
    v_pk_add_f32 v[62:63], v[62:63], v[66:67]
    v_pk_add_f32 v[60:61], v[60:61], v[62:63]
    v_add_f32 v60, v60, v61
    s_waitcnt vmcnt(8)
    v_cmp_eq_u32 vcc, 0, v181
    s_nop 1
    s_cbranch_vccz L_nc_a
    v_mov_b32 v8, 0
    s_mov_b32 s30, 0
L_poll_nca:
    buffer_load_dword v181, v8, s[36:39], 0 offen sc1
    s_waitcnt vmcnt(0)
    v_cmp_gt_u32 vcc, 1, v181
    s_add_u32 s30, s30, 1
    s_cmp_ge_u32 s30, 20000
    s_cbranch_scc1 L_pd_nca
    s_cmp_eq_u64 vcc, 0
    s_cbranch_scc1 L_pd_nca
    s_sleep 2
    s_branch L_poll_nca
L_pd_nca:
L_nc_a:
    v_mov_b32 v61, v181
    v_lshlrev_b32 v8, 3, v0
    s_lshl_b32 s22, s31, 13
    s_lshr_b32 s23, s2, 2
    s_lshl_b32 s23, s23, 9
    s_add_u32 s22, s22, s23
    s_add_u32 s22, s22, 65536
    buffer_store_dwordx2 v[60:61], v8, s[12:15], s22 offen sc1
    s_branch L_a2_back
L_ncw:
    v_mov_b32 v8, 0
    s_mov_b32 s30, 0
L_poll_ncw:
    buffer_load_dword v181, v8, s[36:39], 0 offen sc1
    s_waitcnt vmcnt(0)
    v_cmp_gt_u32 vcc, 1, v181
    s_add_u32 s30, s30, 1
    s_cmp_ge_u32 s30, 20000
    s_cbranch_scc1 L_pd_ncw
    s_cmp_eq_u64 vcc, 0
    s_cbranch_scc1 L_pd_ncw
    s_sleep 2
    s_branch L_poll_ncw
L_pd_ncw:
    s_branch L_ncw_back
L_mp:
    s_mov_b32 s30, 0
L_poll_mp:
    s_add_u32 s24, s46, 0
    buffer_load_dwordx4 v[160:163], v2, s[12:15], s24 offen offset:0 sc1
    buffer_load_dwordx4 v[240:243], v2, s[12:15], s24 offen offset:1024 sc1
    s_add_u32 s24, s46, 8192
    buffer_load_dwordx4 v[164:167], v2, s[12:15], s24 offen offset:0 sc1
    buffer_load_dwordx4 v[244:247], v2, s[12:15], s24 offen offset:1024 sc1
    s_add_u32 s24, s46, 16384
    buffer_load_dwordx4 v[168:171], v2, s[12:15], s24 offen offset:0 sc1
    buffer_load_dwordx4 v[248:251], v2, s[12:15], s24 offen offset:1024 sc1
    s_add_u32 s24, s46, 24576
    buffer_load_dwordx4 v[172:175], v2, s[12:15], s24 offen offset:0 sc1
    buffer_load_dwordx4 v[252:255], v2, s[12:15], s24 offen offset:1024 sc1
    s_waitcnt vmcnt(7)
    v_xor_b32 v8, v161, v181
    s_waitcnt vmcnt(6)
    v_bitop3_b32 v8, v241, v181, v8 bitop3:0xbe
    v_bitop3_b32 v8, v163, v181, v8 bitop3:0xbe
    v_bitop3_b32 v8, v243, v181, v8 bitop3:0xbe
    s_waitcnt vmcnt(5)
    v_bitop3_b32 v8, v165, v181, v8 bitop3:0xbe
    s_waitcnt vmcnt(4)
    v_bitop3_b32 v8, v245, v181, v8 bitop3:0xbe
    v_bitop3_b32 v8, v167, v181, v8 bitop3:0xbe
    v_bitop3_b32 v8, v247, v181, v8 bitop3:0xbe
    s_waitcnt vmcnt(3)
    v_bitop3_b32 v8, v169, v181, v8 bitop3:0xbe
    s_waitcnt vmcnt(2)
    v_bitop3_b32 v8, v249, v181, v8 bitop3:0xbe
    v_bitop3_b32 v8, v171, v181, v8 bitop3:0xbe
    v_bitop3_b32 v8, v251, v181, v8 bitop3:0xbe
    s_waitcnt vmcnt(1)
    v_bitop3_b32 v8, v173, v181, v8 bitop3:0xbe
    s_waitcnt vmcnt(0)
    v_bitop3_b32 v8, v253, v181, v8 bitop3:0xbe
    v_bitop3_b32 v8, v175, v181, v8 bitop3:0xbe
    v_bitop3_b32 v8, v255, v181, v8 bitop3:0xbe
    v_cmp_ne_u32 vcc, 0, v8
    s_add_u32 s30, s30, 1
    s_cmp_ge_u32 s30, 20000
    s_cbranch_scc1 L_pd_mp
    s_cmp_eq_u64 vcc, 0
    s_cbranch_scc1 L_pd_mp
    s_sleep 2
    s_branch L_poll_mp
L_pd_mp:
    s_branch L_mp_back
L_sp2:
    s_waitcnt vmcnt(26)
    v_mfma_f32_16x16x32_bf16 v[144:147], v[64:67], v[32:35], 0
    v_lshlrev_b32 v16, 16, v48
    v_and_b32 v17, 0xffff0000, v48
    v_mfma_f32_16x16x32_bf16 v[148:151], v[96:99], v[32:35], 0
    v_lshlrev_b32 v18, 16, v49
    v_and_b32 v19, 0xffff0000, v49
    v_mfma_f32_16x16x32_bf16 v[152:155], v[80:83], v[32:35], 0
    v_lshlrev_b32 v20, 16, v50
    v_and_b32 v21, 0xffff0000, v50
    v_mfma_f32_16x16x32_bf16 v[156:159], v[112:115], v[32:35], 0
    v_lshlrev_b32 v22, 16, v51
    v_and_b32 v23, 0xffff0000, v51
    s_waitcnt vmcnt(22)
    v_mfma_f32_16x16x32_bf16 v[144:147], v[68:71], v[36:39], v[144:147]
    v_lshlrev_b32 v24, 16, v52
    v_and_b32 v25, 0xffff0000, v52
    v_mfma_f32_16x16x32_bf16 v[148:151], v[100:103], v[36:39], v[148:151]
    v_lshlrev_b32 v26, 16, v53
    v_and_b32 v27, 0xffff0000, v53
    v_mfma_f32_16x16x32_bf16 v[152:155], v[84:87], v[36:39], v[152:155]
    v_lshlrev_b32 v28, 16, v54
    v_and_b32 v29, 0xffff0000, v54
    v_mfma_f32_16x16x32_bf16 v[156:159], v[116:119], v[36:39], v[156:159]
    v_lshlrev_b32 v30, 16, v55
    v_and_b32 v31, 0xffff0000, v55
    s_waitcnt vmcnt(18)
    v_mfma_f32_16x16x32_bf16 v[144:147], v[72:75], v[40:43], v[144:147]
    v_mul_f32 v176, v128, v16
    v_mul_f32 v177, v128, v17
    v_mfma_f32_16x16x32_bf16 v[148:151], v[104:107], v[40:43], v[148:151]
    v_fma_f32 v176, -v132, v17, v176
    v_fmac_f32 v177, v132, v16
    v_mfma_f32_16x16x32_bf16 v[152:155], v[88:91], v[40:43], v[152:155]
    v_mul_f32 v178, v129, v18
    v_mul_f32 v179, v129, v19
    v_mfma_f32_16x16x32_bf16 v[156:159], v[120:123], v[40:43], v[156:159]
    v_fma_f32 v178, -v133, v19, v178
    v_fmac_f32 v179, v133, v18
    s_waitcnt vmcnt(14)
    v_mfma_f32_16x16x32_bf16 v[144:147], v[76:79], v[44:47], v[144:147]
    v_mul_f32 v180, v130, v20
    v_mul_f32 v181, v130, v21
    v_mfma_f32_16x16x32_bf16 v[148:151], v[108:111], v[44:47], v[148:151]
    v_fma_f32 v180, -v134, v21, v180
    v_fmac_f32 v181, v134, v20
    v_mfma_f32_16x16x32_bf16 v[152:155], v[92:95], v[44:47], v[152:155]
    v_mul_f32 v182, v131, v22
    v_mul_f32 v183, v131, v23
    v_mfma_f32_16x16x32_bf16 v[156:159], v[124:127], v[44:47], v[156:159]
    v_fma_f32 v182, -v135, v23, v182
    v_fmac_f32 v183, v135, v22
    v_mul_f32 v184, v136, v24
    v_mul_f32 v185, v136, v25
    v_fma_f32 v184, -v140, v25, v184
    v_fmac_f32 v185, v140, v24
    v_mul_f32 v186, v137, v26
    v_mul_f32 v187, v137, v27
    v_fma_f32 v186, -v141, v27, v186
    v_fmac_f32 v187, v141, v26
    v_mul_f32 v188, v138, v28
    v_mul_f32 v189, v138, v29
    v_fma_f32 v188, -v142, v29, v188
    v_fmac_f32 v189, v142, v28
    v_mul_f32 v190, v139, v30
    v_mul_f32 v191, v139, v31
    v_fma_f32 v190, -v143, v31, v190
    v_fmac_f32 v191, v143, v30
    s_waitcnt vmcnt(13)
    v_lshlrev_b32 v16, 16, v56
    v_and_b32 v17, 0xffff0000, v56
    v_lshlrev_b32 v18, 16, v57
    v_and_b32 v19, 0xffff0000, v57
    v_lshlrev_b32 v20, 16, v58
    v_and_b32 v21, 0xffff0000, v58
    v_lshlrev_b32 v22, 16, v59
    v_and_b32 v23, 0xffff0000, v59
    s_waitcnt vmcnt(12)
    v_lshlrev_b32 v24, 16, v60
    v_and_b32 v25, 0xffff0000, v60
    v_lshlrev_b32 v26, 16, v61
    v_and_b32 v27, 0xffff0000, v61
    v_lshlrev_b32 v28, 16, v62
    v_and_b32 v29, 0xffff0000, v62
    v_lshlrev_b32 v30, 16, v63
    v_and_b32 v31, 0xffff0000, v63
    v_fmac_f32 v176, v144, v16
    v_fmac_f32 v177, v144, v17
    v_fma_f32 v176, -v148, v17, v176
    v_fmac_f32 v177, v148, v16
    v_fmac_f32 v178, v145, v18
    v_fmac_f32 v179, v145, v19
    v_fma_f32 v178, -v149, v19, v178
    v_fmac_f32 v179, v149, v18
    v_fmac_f32 v180, v146, v20
    v_fmac_f32 v181, v146, v21
    v_fma_f32 v180, -v150, v21, v180
    v_fmac_f32 v181, v150, v20
    v_fmac_f32 v182, v147, v22
    v_fmac_f32 v183, v147, v23
    v_fma_f32 v182, -v151, v23, v182
    v_fmac_f32 v183, v151, v22
    v_fmac_f32 v184, v152, v24
    v_fmac_f32 v185, v152, v25
    v_fma_f32 v184, -v156, v25, v184
    v_fmac_f32 v185, v156, v24
    v_fmac_f32 v186, v153, v26
    v_fmac_f32 v187, v153, v27
    v_fma_f32 v186, -v157, v27, v186
    v_fmac_f32 v187, v157, v26
    v_fmac_f32 v188, v154, v28
    v_fmac_f32 v189, v154, v29
    v_fma_f32 v188, -v158, v29, v188
    v_fmac_f32 v189, v158, v28
    v_fmac_f32 v190, v155, v30
    v_fmac_f32 v191, v155, v31
    v_fma_f32 v190, -v159, v31, v190
    v_fmac_f32 v191, v159, v30
    s_branch L_sp2e
    s_branch L_sp2_back
L_p0b:
    s_set_gpr_idx_on s28, gpr_idx(SRC0)
    s_nop 0
    v_mov_b32 v112, v128
    v_mov_b32 v113, v144
    v_mov_b32 v114, v160
    v_mov_b32 v115, v176
    s_set_gpr_idx_off
    ds_write_b128 v9, v[112:115] offset:35840
    s_set_gpr_idx_on s28, gpr_idx(SRC0)
    s_nop 0
    v_mov_b32 v116, v129
    v_mov_b32 v117, v145
    v_mov_b32 v118, v161
    v_mov_b32 v119, v177
    s_set_gpr_idx_off
    ds_write_b128 v9, v[116:119] offset:36352
    s_set_gpr_idx_on s28, gpr_idx(SRC0)
    s_nop 0
    v_mov_b32 v120, v130
    v_mov_b32 v121, v146
    v_mov_b32 v122, v162
    v_mov_b32 v123, v178
    s_set_gpr_idx_off
    ds_write_b128 v9, v[120:123] offset:39936
    s_set_gpr_idx_on s28, gpr_idx(SRC0)
    s_nop 0
    v_mov_b32 v124, v131
    v_mov_b32 v125, v147
    v_mov_b32 v126, v163
    v_mov_b32 v127, v179
    s_set_gpr_idx_off
    ds_write_b128 v9, v[124:127] offset:40448
    buffer_load_dwordx4 v[128:131], v2, s[36:39], s52 offen offset:0 sc1
    buffer_load_dwordx4 v[132:135], v2, s[36:39], s53 offen offset:0 sc1
    buffer_load_dwordx4 v[136:139], v2, s[36:39], s52 offen offset:1024 sc1
    buffer_load_dwordx4 v[140:143], v2, s[36:39], s53 offen offset:1024 sc1
    buffer_load_dwordx4 v[144:147], v2, s[36:39], s52 offen offset:2048 sc1
    buffer_load_dwordx4 v[148:151], v2, s[36:39], s53 offen offset:2048 sc1
    buffer_load_dwordx4 v[152:155], v2, s[36:39], s52 offen offset:3072 sc1
    s_add_u32 s52, s52, 4096
    buffer_load_dwordx4 v[156:159], v2, s[36:39], s53 offen offset:3072 sc1
    s_add_u32 s53, s53, 4096
    buffer_load_dwordx4 v[160:163], v2, s[36:39], s52 offen offset:0 sc1
    buffer_load_dwordx4 v[164:167], v2, s[36:39], s53 offen offset:0 sc1
    buffer_load_dwordx4 v[168:171], v2, s[36:39], s52 offen offset:1024 sc1
    buffer_load_dwordx4 v[172:175], v2, s[36:39], s53 offen offset:1024 sc1
    buffer_load_dwordx4 v[176:179], v2, s[36:39], s52 offen offset:2048 sc1
    buffer_load_dwordx4 v[180:183], v2, s[36:39], s52 offen offset:3072 sc1
    s_add_u32 s52, s52, 4096
    ds_read_b128 v[24:27], v2 offset:0
    ds_read_b128 v[28:31], v2 offset:1024
    ds_read_b128 v[32:35], v2 offset:2048
    ds_read_b128 v[36:39], v2 offset:3072
    ds_read_b128 v[16:19], v2 offset:4096
    s_branch L_p0e
    s_branch L_p0b_back
L_rdy:
    s_mov_b32 s30, 0
L_poll_rdy:
    buffer_load_dwordx2 v[14:15], v11, s[12:15], 0 offen sc1
    s_waitcnt vmcnt(0)
    v_cmp_ne_u32 vcc, s94, v14
    s_add_u32 s30, s30, 1
    s_cmp_ge_u32 s30, 20000
    s_cbranch_scc1 L_pd_rdy
    s_cmp_eq_u64 vcc, 0
    s_cbranch_scc1 L_pd_rdy
    s_sleep 2
    s_branch L_poll_rdy
L_pd_rdy:
    s_branch L_rdy_back
L_in0:
    s_mov_b32 s30, 0
L_poll_in0:
    buffer_load_dwordx4 v[208:211], v2, s[12:15], s24 offen offset:0 sc1
    buffer_load_dwordx4 v[212:215], v2, s[12:15], s24 offen offset:1024 sc1
    s_waitcnt vmcnt(1)
    v_max3_u32 v8, v208, v209, v210
    s_waitcnt vmcnt(0)
    v_max3_u32 v8, v8, v211, v212
    v_max3_u32 v8, v8, v213, v214
    v_max_u32 v8, v8, v215
    v_cmp_eq_u32 vcc, -1, v8
    s_add_u32 s30, s30, 1
    s_cmp_ge_u32 s30, 20000
    s_cbranch_scc1 L_pd_in0
    s_cmp_eq_u64 vcc, 0
    s_cbranch_scc1 L_pd_in0
    s_sleep 2
    s_branch L_poll_in0
L_pd_in0:
    s_branch L_in0_back
L_in1:
    s_mov_b32 s30, 0
L_poll_in1:
    buffer_load_dwordx4 v[216:219], v2, s[12:15], s25 offen offset:0 sc1
    buffer_load_dwordx4 v[220:223], v2, s[12:15], s25 offen offset:1024 sc1
    s_waitcnt vmcnt(1)
    v_max3_u32 v8, v216, v217, v218
    s_waitcnt vmcnt(0)
    v_max3_u32 v8, v8, v219, v220
    v_max3_u32 v8, v8, v221, v222
    v_max_u32 v8, v8, v223
    v_cmp_eq_u32 vcc, -1, v8
    s_add_u32 s30, s30, 1
    s_cmp_ge_u32 s30, 20000
    s_cbranch_scc1 L_pd_in1
    s_cmp_eq_u64 vcc, 0
    s_cbranch_scc1 L_pd_in1
    s_sleep 2
    s_branch L_poll_in1
L_pd_in1:
    s_branch L_in1_back
L_in2:
    s_mov_b32 s30, 0
L_poll_in2:
    buffer_load_dwordx4 v[224:227], v2, s[12:15], s26 offen offset:0 sc1
    buffer_load_dwordx4 v[228:231], v2, s[12:15], s26 offen offset:1024 sc1
    s_waitcnt vmcnt(1)
    v_max3_u32 v8, v224, v225, v226
    s_waitcnt vmcnt(0)
    v_max3_u32 v8, v8, v227, v228
    v_max3_u32 v8, v8, v229, v230
    v_max_u32 v8, v8, v231
    v_cmp_eq_u32 vcc, -1, v8
    s_add_u32 s30, s30, 1
    s_cmp_ge_u32 s30, 20000
    s_cbranch_scc1 L_pd_in2
    s_cmp_eq_u64 vcc, 0
    s_cbranch_scc1 L_pd_in2
    s_sleep 2
    s_branch L_poll_in2
L_pd_in2:
    s_branch L_in2_back
.section .rodata,"a"
.p2align 6
.amdhsa_kernel adaLN_cond__spectral_gfnet__dense_activation_mish__prompt_kernel
  .amdhsa_next_free_vgpr 512
  .amdhsa_next_free_sgpr 102
  .amdhsa_accum_offset 256
  .amdhsa_group_segment_fixed_size 0
  .amdhsa_kernarg_size 96
  .amdhsa_user_sgpr_count 2
  .amdhsa_user_sgpr_kernarg_segment_ptr 1
  .amdhsa_system_sgpr_workgroup_id_x 1
  .amdhsa_float_denorm_mode_32 3
.end_amdhsa_kernel
.text

.p2align 8
.type L_tables,@object
L_tables:
.long 0x00003f80,0x00003f80,0x00003f80,0x00003f80,0x00003f80,0x00003f6d,0x00003f35,0x00003ec4
.long 0x00003f80,0x00003f35,0x0000248d,0x0000bf35,0x00003f80,0x00003ec4,0x0000bf35,0x0000bf6d
.long 0x00003f80,0x0000248d,0x0000bf80,0x0000a554,0x00003f80,0x0000bec4,0x0000bf35,0x00003f6d
.long 0x00003f80,0x0000bf35,0x0000a554,0x00003f35,0x00003f80,0x0000bf6d,0x00003f35,0x0000bec4
.long 0x3f800000,0x3f7b0000,0x3f6d0000,0x3f550000,0x3f800000,0x3f550000,0x3ec40000,0xbe480000
.long 0x3f800000,0x3f0e0000,0xbec40000,0xbf7b0000,0x3f800000,0x3e480000,0xbf6d0000,0xbf0e0000
.long 0x3f800000,0xbe480000,0xbf6d0000,0x3f0e0000,0x3f800000,0xbf0e0000,0xbec40000,0x3f7b0000
.long 0x3f800000,0xbf550000,0x3ec40000,0x3e480000,0x3f800000,0xbf7b0000,0x3f6d0000,0xbf550000
.long 0x00003f80,0x00003f80,0x00003f80,0x00003f80,0x0000248d,0x0000bec4,0x0000bf35,0x0000bf6d
.long 0x0000bf80,0x0000bf35,0x0000a554,0x00003f35,0x0000a554,0x00003f6d,0x00003f35,0x0000bec4
.long 0x00003f80,0x000025b0,0x0000bf80,0x0000a5f7,0x000025b0,0x0000bf6d,0x00003f35,0x00003ec4
.long 0x0000bf80,0x00003f35,0x0000261f,0x0000bf35,0x0000a5f7,0x00003ec4,0x0000bf35,0x00003f6d
.long 0x3f350000,0x3f0e0000,0x3ec40000,0x3e480000,0xbf350000,0xbf7b0000,0xbf6d0000,0xbf0e0000
.long 0xbf350000,0x3e480000,0x3f6d0000,0x3f550000,0x3f350000,0x3f550000,0xbec40000,0xbf7b0000
.long 0x3f350000,0xbf550000,0xbec40000,0x3f7b0000,0xbf350000,0xbe480000,0x3f6d0000,0xbf550000
.long 0xbf350000,0x3f7b0000,0xbf6d0000,0x3f0e0000,0x3f350000,0xbf0e0000,0x3ec40000,0xbe480000
.long 0x00003f80,0x00003f80,0x00003f80,0x00003f80,0x0000bf80,0x0000bf6d,0x0000bf35,0x0000bec4
.long 0x00003f80,0x00003f35,0x000025b0,0x0000bf35,0x0000bf80,0x0000bec4,0x00003f35,0x00003f6d
.long 0x00003f80,0x0000261f,0x0000bf80,0x0000a731,0x0000bf80,0x00003ec4,0x00003f35,0x0000bf6d
.long 0x00003f80,0x0000bf35,0x0000a742,0x00003f35,0x0000bf80,0x00003f6d,0x0000bf35,0x00003ec4
.long 0x248d0000,0xbe480000,0xbec40000,0xbf0e0000,0xa5540000,0x3f0e0000,0x3f6d0000,0x3f7b0000
.long 0x25b00000,0xbf550000,0xbf6d0000,0xbe480000,0xa5f70000,0x3f7b0000,0x3ec40000,0xbf550000
.long 0x261f0000,0xbf7b0000,0x3ec40000,0x3f550000,0xa7310000,0x3f550000,0xbf6d0000,0x3e480000
.long 0xa68d0000,0xbf0e0000,0x3f6d0000,0xbf7b0000,0xa7420000,0x3e480000,0xbec40000,0x3f0e0000
.long 0x00003f80,0x00003f80,0x00003f80,0x00003f80,0x0000a554,0x00003ec4,0x00003f35,0x00003f6d
.long 0x0000bf80,0x0000bf35,0x0000a5f7,0x00003f35,0x0000261f,0x0000bf6d,0x0000bf35,0x00003ec4
.long 0x00003f80,0x0000a68d,0x0000bf80,0x0000a742,0x0000a742,0x00003f6d,0x0000bf35,0x0000bec4
.long 0x0000bf80,0x00003f35,0x0000a60d,0x0000bf35,0x0000a60d,0x0000bec4,0x00003f35,0x0000bf6d
.long 0xbf350000,0xbf550000,0xbf6d0000,0xbf7b0000,0x3f350000,0x3e480000,0xbec40000,0xbf550000
.long 0x3f350000,0x3f7b0000,0x3ec40000,0xbf0e0000,0xbf350000,0x3f0e0000,0x3f6d0000,0xbe480000
.long 0xbf350000,0xbf0e0000,0x3f6d0000,0x3e480000,0x3f350000,0xbf7b0000,0x3ec40000,0x3f0e0000
.long 0x3f350000,0xbe480000,0xbec40000,0x3f550000,0xbf350000,0x3f550000,0xbf6d0000,0x3f7b0000
.long 0x00003f80,0x0000bf80,0x00003f80,0x0000bf80,0x00008000,0x0000bec4,0x0000bf35,0x0000bf6d
.long 0x00008000,0x0000bf35,0x0000bf80,0x0000bf35,0x00008000,0x0000bf6d,0x0000bf35,0x00003ec4
.long 0x00008000,0x0000bf80,0x0000a50d,0x00003f80,0x00008000,0x0000bf6d,0x00003f35,0x00003ec4
.long 0x00008000,0x0000bf35,0x00003f80,0x0000bf35,0x00008000,0x0000bec4,0x00003f35,0x0000bf6d
.long 0x80000000,0xbe480000,0xbec40000,0xbf0e0000,0x80000000,0xbf0e0000,0xbf6d0000,0xbf7b0000
.long 0x80000000,0xbf550000,0xbf6d0000,0xbe480000,0x80000000,0xbf7b0000,0xbec40000,0x3f550000
.long 0x80000000,0xbf7b0000,0x3ec40000,0x3f550000,0x80000000,0xbf550000,0x3f6d0000,0xbe480000
.long 0x80000000,0xbf0e0000,0x3f6d0000,0xbf7b0000,0x80000000,0xbe480000,0x3ec40000,0xbf0e0000
.long 0x00003f80,0x0000bf80,0x00003f80,0x0000bf80,0x0000bf80,0x0000bf6d,0x0000bf35,0x0000bec4
.long 0x0000a50d,0x00003f35,0x00003f80,0x00003f35,0x00003f80,0x00003ec4,0x0000bf35,0x0000bf6d
.long 0x0000258d,0x0000bf80,0x0000a5d4,0x00003f80,0x0000bf80,0x00003ec4,0x00003f35,0x0000bf6d
.long 0x0000a5d4,0x00003f35,0x0000bf80,0x00003f35,0x00003f80,0x0000bf6d,0x00003f35,0x0000bec4
.long 0xbf350000,0xbf550000,0xbf6d0000,0xbf7b0000,0xbf350000,0xbe480000,0x3ec40000,0x3f550000
.long 0x3f350000,0x3f7b0000,0x3ec40000,0xbf0e0000,0x3f350000,0xbf0e0000,0xbf6d0000,0x3e480000
.long 0xbf350000,0xbf0e0000,0x3f6d0000,0x3e480000,0xbf350000,0x3f7b0000,0xbec40000,0xbf0e0000
.long 0x3f350000,0xbe480000,0xbec40000,0x3f550000,0x3f350000,0xbf550000,0x3f6d0000,0xbf7b0000
.long 0x00003f80,0x0000bf80,0x00003f80,0x0000bf80,0x0000a50d,0x00003ec4,0x00003f35,0x00003f6d
.long 0x0000258d,0x0000bf35,0x0000bf80,0x0000bf35,0x0000a5d4,0x00003f6d,0x00003f35,0x0000bec4
.long 0x0000260d,0x0000bf80,0x0000a630,0x00003f80,0x0000a630,0x00003f6d,0x0000bf35,0x0000bec4
.long 0x00002654,0x0000bf35,0x00003f80,0x0000bf35,0x0000a677,0x00003ec4,0x0000bf35,0x00003f6d
.long 0xbf800000,0xbf7b0000,0xbf6d0000,0xbf550000,0x3f800000,0x3f550000,0x3ec40000,0xbe480000
.long 0xbf800000,0xbf0e0000,0x3ec40000,0x3f7b0000,0x3f800000,0x3e480000,0xbf6d0000,0xbf0e0000
.long 0xbf800000,0x3e480000,0x3f6d0000,0xbf0e0000,0x3f800000,0xbf0e0000,0xbec40000,0x3f7b0000
.long 0xbf800000,0x3f550000,0xbec40000,0xbe480000,0x3f800000,0xbf7b0000,0x3f6d0000,0xbf550000
.long 0x00003f80,0x0000bf80,0x00003f80,0x0000bf80,0x00003f80,0x00003f6d,0x00003f35,0x00003ec4
.long 0x0000a5d4,0x00003f35,0x00003f80,0x00003f35,0x0000bf80,0x0000bec4,0x00003f35,0x00003f6d
.long 0x00002654,0x0000bf80,0x0000a677,0x00003f80,0x00003f80,0x0000bec4,0x0000bf35,0x00003f6d
.long 0x0000a69f,0x00003f35,0x0000bf80,0x00003f35,0x0000bf80,0x00003f6d,0x0000bf35,0x00003ec4
.long 0xbf350000,0xbf0e0000,0xbec40000,0xbe480000,0xbf350000,0xbf7b0000,0xbf6d0000,0xbf0e0000
.long 0x3f350000,0xbe480000,0xbf6d0000,0xbf550000,0x3f350000,0x3f550000,0xbec40000,0xbf7b0000
.long 0xbf350000,0x3f550000,0x3ec40000,0xbf7b0000,0xbf350000,0xbe480000,0x3f6d0000,0xbf550000
.long 0x3f350000,0xbf7b0000,0x3f6d0000,0xbf0e0000,0x3f350000,0xbf0e0000,0x3ec40000,0xbe480000
.long 0x00003f80,0x00003f80,0x00003f80,0x00003f80,0x00003f80,0x3ec43f6d,0x3f353f35,0x3f6d3ec4
.long 0x00003f80,0x3f353f35,0x3f80248d,0x3f35bf35,0x00003f80,0x3f6d3ec4,0x3f35bf35,0xbec4bf6d
.long 0x00003f80,0x3f80248d,0x250dbf80,0xbf80a554,0x00003f80,0x3f6dbec4,0xbf35bf35,0xbec43f6d
.long 0x00003f80,0x3f35bf35,0xbf80a554,0x3f353f35,0x00003f80,0x3ec4bf6d,0xbf353f35,0x3f6dbec4
.long 0x00003f80,0x250dbf80,0xa58d3f80,0x25d4bf80,0x00003f80,0xbec4bf6d,0x3f353f35,0xbf6dbec4
.long 0x00003f80,0xbf35bf35,0x3f8025b0,0xbf353f35,0x00003f80,0xbf6dbec4,0x3f35bf35,0x3ec43f6d
.long 0x00003f80,0xbf80a554,0x25d4bf80,0x3f80261f,0x00003f80,0xbf6d3ec4,0xbf35bf35,0x3ec4bf6d
.long 0x00003f80,0xbf353f35,0xbf80a5f7,0xbf35bf35,0x00003f80,0xbec43f6d,0xbf353f35,0xbf6d3ec4
.long 0x00003f80,0x00003f80,0x00003f80,0x00003f80,0x3f80248d,0x3f6dbec4,0x3f35bf35,0x3ec4bf6d
.long 0x250dbf80,0xbf35bf35,0xbf80a554,0xbf353f35,0xbf80a554,0xbec43f6d,0x3f353f35,0x3f6dbec4
.long 0xa58d3f80,0x3f8025b0,0x25d4bf80,0xbf80a5f7,0x3f8025b0,0xbec4bf6d,0xbf353f35,0x3f6d3ec4
.long 0x25d4bf80,0xbf353f35,0x3f80261f,0xbf35bf35,0xbf80a5f7,0x3f6d3ec4,0xbf35bf35,0x3ec43f6d
.long 0xa60d3f80,0x2630bf80,0xa6543f80,0x2677bf80,0x3f80261f,0xbf6d3ec4,0x3f35bf35,0xbec43f6d
.long 0x2630bf80,0x3f353f35,0xbf80a742,0x3f35bf35,0xbf80a731,0x3ec4bf6d,0x3f353f35,0xbf6d3ec4
.long 0xa6543f80,0xbf80a742,0x269fbf80,0x3f80a60d,0x3f80a68d,0x3ec43f6d,0xbf353f35,0xbf6dbec4
.long 0x2677bf80,0x3f35bf35,0x3f80a60d,0x3f353f35,0xbf80a742,0xbf6dbec4,0xbf35bf35,0xbec4bf6d
.long 0x00003f80,0x00003f80,0x00003f80,0x00003f80,0x250dbf80,0xbec4bf6d,0xbf35bf35,0xbf6dbec4
.long 0xa58d3f80,0x3f353f35,0x3f8025b0,0x3f35bf35,0x25d4bf80,0xbf6dbec4,0xbf353f35,0x3ec43f6d
.long 0xa60d3f80,0x3f80261f,0x2630bf80,0xbf80a731,0x2630bf80,0xbf6d3ec4,0x3f353f35,0x3ec4bf6d
.long 0xa6543f80,0x3f35bf35,0xbf80a742,0x3f353f35,0x2677bf80,0xbec43f6d,0x3f35bf35,0xbf6d3ec4
.long 0xa68d3f80,0x269fbf80,0xa6b03f80,0x27b1bf80,0x269fbf80,0x3ec43f6d,0xbf35bf35,0x3f6d3ec4
.long 0xa6b03f80,0xbf35bf35,0x3f80a58e,0xbf353f35,0x27b1bf80,0x3f6d3ec4,0xbf353f35,0xbec4bf6d
.long 0xa6d43f80,0xbf80a777,0x27c2bf80,0x3f802804,0xa70dbf80,0x3f6dbec4,0x3f353f35,0xbec43f6d
.long 0xa6f73f80,0xbf353f35,0xbf80a78d,0xbf35bf35,0x27c2bf80,0x3ec4bf6d,0x3f35bf35,0x3f6dbec4
.long 0x00003f80,0x00003f80,0x00003f80,0x00003f80,0xbf80a554,0xbf6d3ec4,0xbf353f35,0xbec43f6d
.long 0x25d4bf80,0xbf35bf35,0xbf80a5f7,0xbf353f35,0x3f80261f,0x3ec4bf6d,0xbf35bf35,0xbf6d3ec4
.long 0xa6543f80,0x3f80a68d,0x2677bf80,0xbf80a742,0xbf80a742,0x3ec43f6d,0x3f35bf35,0xbf6dbec4
.long 0x269fbf80,0xbf353f35,0x3f80a60d,0xbf35bf35,0x3f80a60d,0xbf6dbec4,0x3f353f35,0xbec4bf6d
.long 0xa6d43f80,0xa70dbf80,0xa6f73f80,0x27c2bf80,0xbf80a777,0x3f6dbec4,0xbf353f35,0x3ec4bf6d
.long 0x27c2bf80,0x3f353f35,0xbf80a78d,0x3f35bf35,0x3f80258d,0xbec43f6d,0xbf35bf35,0x3f6dbec4
.long 0xa71f3f80,0xbf802754,0xa68dbf80,0x3f802889,0xbf80a796,0xbec4bf6d,0x3f35bf35,0x3f6d3ec4
.long 0xa68dbf80,0x3f35bf35,0x3f802816,0x3f353f35,0x3f80268d,0x3f6d3ec4,0x3f353f35,0x3ec43f6d
.long 0x3f808000,0x3f808000,0x3f808000,0x3f808000,0x3f808000,0x3f6dbec4,0x3f35bf35,0x3ec4bf6d
.long 0x3f808000,0x3f35bf35,0x248dbf80,0xbf35bf35,0x3f808000,0x3ec4bf6d,0xbf35bf35,0xbf6d3ec4
.long 0x3f808000,0x248dbf80,0xbf80a50d,0xa5543f80,0x3f808000,0xbec4bf6d,0xbf353f35,0x3f6d3ec4
.long 0x3f808000,0xbf35bf35,0xa5543f80,0x3f35bf35,0x3f808000,0xbf6dbec4,0x3f353f35,0xbec4bf6d
.long 0xbf800000,0x3f80250d,0xbf80a58d,0x3f8025d4,0xbf800000,0x3f6dbec4,0xbf353f35,0x3ec4bf6d
.long 0xbf800000,0x3f35bf35,0xa5b03f80,0xbf35bf35,0xbf800000,0x3ec4bf6d,0x3f353f35,0xbf6d3ec4
.long 0xbf800000,0x2554bf80,0x3f8025d4,0xa61f3f80,0xbf800000,0xbec4bf6d,0x3f35bf35,0x3f6d3ec4
.long 0xbf800000,0xbf35bf35,0x25f7bf80,0x3f35bf35,0xbf800000,0xbf6dbec4,0xbf35bf35,0xbec4bf6d
.long 0x3f808000,0x3f808000,0x3f808000,0x3f808000,0x248dbf80,0xbec4bf6d,0xbf35bf35,0xbf6dbec4
.long 0xbf80a50d,0xbf353f35,0xa5543f80,0x3f353f35,0xa5543f80,0x3f6d3ec4,0x3f35bf35,0xbec4bf6d
.long 0x3f80258d,0x25b0bf80,0xbf80a5d4,0xa5f73f80,0x25b0bf80,0xbf6d3ec4,0x3f353f35,0x3ec4bf6d
.long 0xbf80a5d4,0x3f353f35,0x261fbf80,0xbf353f35,0xa5f73f80,0x3ec4bf6d,0xbf353f35,0x3f6dbec4
.long 0xbf80a60d,0x3f802630,0xbf80a654,0x3f802677,0xa61f3f80,0xbec4bf6d,0x3f353f35,0xbf6dbec4
.long 0x3f802630,0xbf353f35,0x2742bf80,0x3f353f35,0x2731bf80,0x3f6d3ec4,0xbf353f35,0xbec4bf6d
.long 0xbf80a654,0x2742bf80,0x3f80269f,0x260d3f80,0x268d3f80,0xbf6d3ec4,0xbf35bf35,0x3ec4bf6d
.long 0x3f802677,0x3f353f35,0x260d3f80,0xbf353f35,0x2742bf80,0x3ec4bf6d,0x3f35bf35,0x3f6dbec4
.long 0x3f808000,0x3f808000,0x3f808000,0x3f808000,0xbf80a50d,0xbf6d3ec4,0xbf353f35,0xbec43f6d
.long 0x3f80258d,0x3f35bf35,0x25b0bf80,0xbf35bf35,0xbf80a5d4,0xbec43f6d,0x3f353f35,0x3f6dbec4
.long 0x3f80260d,0x261fbf80,0xbf80a630,0xa7313f80,0xbf80a630,0x3ec43f6d,0x3f35bf35,0xbf6dbec4
.long 0x3f802654,0xbf35bf35,0xa7423f80,0x3f35bf35,0xbf80a677,0x3f6d3ec4,0xbf35bf35,0x3ec43f6d
.long 0xbf80a68d,0x3f80269f,0xbf80a6b0,0x3f8027b1,0x3f80269f,0xbf6d3ec4,0x3f35bf35,0xbec43f6d
.long 0xbf80a6b0,0x3f35bf35,0x258e3f80,0xbf35bf35,0x3f8027b1,0xbec43f6d,0xbf35bf35,0x3f6dbec4
.long 0xbf80a6d4,0x2777bf80,0x3f8027c2,0xa8043f80,0x3f80a70d,0x3ec43f6d,0xbf353f35,0xbf6dbec4
.long 0xbf80a6f7,0xbf35bf35,0x278dbf80,0x3f35bf35,0x3f8027c2,0x3f6d3ec4,0x3f353f35,0x3ec43f6d
.long 0x3f808000,0x3f808000,0x3f808000,0x3f808000,0xa5543f80,0x3ec43f6d,0x3f353f35,0x3f6d3ec4
.long 0xbf80a5d4,0xbf353f35,0xa5f73f80,0x3f353f35,0x261fbf80,0xbf6dbec4,0xbf353f35,0x3ec43f6d
.long 0x3f802654,0xa68dbf80,0xbf80a677,0xa7423f80,0xa7423f80,0x3f6dbec4,0xbf35bf35,0xbec43f6d
.long 0xbf80a69f,0x3f353f35,0xa60dbf80,0xbf353f35,0xa60dbf80,0xbec43f6d,0x3f35bf35,0xbf6d3ec4
.long 0xbf80a6d4,0x3f80a70d,0xbf80a6f7,0x3f8027c2,0x2777bf80,0x3ec43f6d,0xbf35bf35,0x3f6d3ec4
.long 0x3f8027c2,0xbf353f35,0x278dbf80,0x3f353f35,0xa58d3f80,0xbf6dbec4,0x3f35bf35,0x3ec43f6d
.long 0xbf80a71f,0xa754bf80,0x3f80a68d,0xa8893f80,0x2796bf80,0x3f6dbec4,0x3f353f35,0xbec43f6d
.long 0x3f80a68d,0x3f353f35,0xa8163f80,0xbf353f35,0xa68d3f80,0xbec43f6d,0xbf353f35,0xbf6d3ec4
.long 0x35803580,0x80003600,0x80003600,0x80003600,0x00000000,0x00000000,0x00000000,0x00000000
.long 0xb5803580,0xb54435ed,0xb5b535b5,0xb5ed3544,0x00000000,0x00000000,0x00000000,0x00000000
.long 0x35803580,0xb5b535b5,0xb6001b0d,0xb5b5b5b5,0x00000000,0x00000000,0x00000000,0x00000000
.long 0xb5803580,0xb5ed3544,0xb5b5b5b5,0x3544b5ed,0x00000000,0x00000000,0x00000000,0x00000000
.long 0x35803580,0xb6001b0d,0x9b8db600,0x36009bd4,0x00000000,0x00000000,0x00000000,0x00000000
.long 0xb5803580,0xb5edb544,0x35b5b5b5,0x354435ed,0x00000000,0x00000000,0x00000000,0x00000000
.long 0x35803580,0xb5b5b5b5,0x36009bd4,0xb5b535b5,0x00000000,0x00000000,0x00000000,0x00000000
.long 0xb5803580,0xb544b5ed,0x35b535b5,0xb5edb544,0x00000000,0x00000000,0x00000000,0x00000000
.long 0x80003600,0x80003600,0x80003600,0x80003600,0x00000000,0x00000000,0x00000000,0x00000000
.long 0xb6001b0d,0xb5edb544,0xb5b5b5b5,0xb544b5ed,0x00000000,0x00000000,0x00000000,0x00000000
.long 0x9b8db600,0x35b5b5b5,0x36009bd4,0x35b535b5,0x00000000,0x00000000,0x00000000,0x00000000
.long 0x36009bd4,0x354435ed,0xb5b535b5,0xb5edb544,0x00000000,0x00000000,0x00000000,0x00000000
.long 0x1c0d3600,0xb6001c30,0x9c54b600,0x36009c77,0x00000000,0x00000000,0x00000000,0x00000000
.long 0xb6001c30,0x3544b5ed,0x35b535b5,0xb5ed3544,0x00000000,0x00000000,0x00000000,0x00000000
.long 0x9c54b600,0x35b535b5,0xb6001c9f,0x35b5b5b5,0x00000000,0x00000000,0x00000000,0x00000000
.long 0x36009c77,0xb5ed3544,0x35b5b5b5,0xb54435ed,0x00000000,0x00000000,0x00000000,0x00000000
.long 0x00000000,0x00000000,0x00000000,0x00000000,0x80003600,0x80003600,0x80003600,0x80003600
.long 0x00000000,0x00000000,0x00000000,0x00000000,0xb4c835fb,0xb58e35d5,0xb5d5358e,0xb5fb34c8
.long 0x00000000,0x00000000,0x00000000,0x00000000,0xb54435ed,0xb5ed3544,0xb5edb544,0xb544b5ed
.long 0x00000000,0x00000000,0x00000000,0x00000000,0xb58e35d5,0xb5fbb4c8,0xb4c8b5fb,0x35d5b58e
.long 0x00000000,0x00000000,0x00000000,0x00000000,0xb5b535b5,0xb5b5b5b5,0x35b5b5b5,0x35b535b5
.long 0x00000000,0x00000000,0x00000000,0x00000000,0xb5d5358e,0xb4c8b5fb,0x35fb34c8,0xb58e35d5
.long 0x00000000,0x00000000,0x00000000,0x00000000,0xb5ed3544,0x3544b5ed,0x354435ed,0xb5edb544
.long 0x00000000,0x00000000,0x00000000,0x00000000,0xb5fb34c8,0x35d5b58e,0xb58e35d5,0x34c8b5fb
.long 0x00000000,0x00000000,0x00000000,0x00000000,0x80003600,0x80003600,0x80003600,0x80003600
.long 0x00000000,0x00000000,0x00000000,0x00000000,0xb5fbb4c8,0xb5d5b58e,0xb58eb5d5,0xb4c8b5fb
.long 0x00000000,0x00000000,0x00000000,0x00000000,0x3544b5ed,0x35edb544,0x35ed3544,0x354435ed
.long 0x00000000,0x00000000,0x00000000,0x00000000,0x35d5358e,0xb4c835fb,0xb5fb34c8,0xb58eb5d5
.long 0x00000000,0x00000000,0x00000000,0x00000000,0xb5b535b5,0xb5b5b5b5,0x35b5b5b5,0x35b535b5
.long 0x00000000,0x00000000,0x00000000,0x00000000,0xb58eb5d5,0x35fbb4c8,0xb4c835fb,0xb5d5b58e
.long 0x00000000,0x00000000,0x00000000,0x00000000,0x35edb544,0xb54435ed,0xb544b5ed,0x35ed3544
.long 0x00000000,0x00000000,0x00000000,0x00000000,0x34c835fb,0xb58eb5d5,0x35d5358e,0xb5fbb4c8
.long 0x35803580,0x9b8db600,0x1c0d3600,0x9c54b600,0x00000000,0x00000000,0x00000000,0x00000000
.long 0xb5803580,0x3544b5ed,0xb5b535b5,0x35edb544,0x00000000,0x00000000,0x00000000,0x00000000
.long 0x35803580,0x35b5b5b5,0xb6001c30,0x35b535b5,0x00000000,0x00000000,0x00000000,0x00000000
.long 0xb5803580,0x35edb544,0xb5b5b5b5,0xb54435ed,0x00000000,0x00000000,0x00000000,0x00000000
.long 0x35803580,0x36009bd4,0x9c54b600,0xb6001c9f,0x00000000,0x00000000,0x00000000,0x00000000
.long 0xb5803580,0x35ed3544,0x35b5b5b5,0xb544b5ed,0x00000000,0x00000000,0x00000000,0x00000000
.long 0x35803580,0x35b535b5,0x36009c77,0x35b5b5b5,0x00000000,0x00000000,0x00000000,0x00000000
.long 0xb5803580,0x354435ed,0x35b535b5,0x35ed3544,0x00000000,0x00000000,0x00000000,0x00000000
.long 0x1c8d3600,0x9cb0b600,0x1cd43600,0x9cf7b600,0x00000000,0x00000000,0x00000000,0x00000000
.long 0xb6001c9f,0x35ed3544,0xb5b5b5b5,0x354435ed,0x00000000,0x00000000,0x00000000,0x00000000
.long 0x9cb0b600,0xb5b535b5,0x36009dc2,0xb5b5b5b5,0x00000000,0x00000000,0x00000000,0x00000000
.long 0x36009db1,0xb544b5ed,0xb5b535b5,0x35ed3544,0x00000000,0x00000000,0x00000000,0x00000000
.long 0x1cd43600,0x36009dc2,0x9d1fb600,0xb6009c8d,0x00000000,0x00000000,0x00000000,0x00000000
.long 0xb6009d0d,0xb54435ed,0x35b535b5,0x35edb544,0x00000000,0x00000000,0x00000000,0x00000000
.long 0x9cf7b600,0xb5b5b5b5,0xb6009c8d,0xb5b535b5,0x00000000,0x00000000,0x00000000,0x00000000
.long 0x36009dc2,0x35edb544,0x35b5b5b5,0x3544b5ed,0x00000000,0x00000000,0x00000000,0x00000000
.long 0x00000000,0x00000000,0x00000000,0x00000000,0xb6001b0d,0x36009bd4,0xb6001c30,0x36009c77
.long 0x00000000,0x00000000,0x00000000,0x00000000,0xb5fbb4c8,0x35d5358e,0xb58eb5d5,0x34c835fb
.long 0x00000000,0x00000000,0x00000000,0x00000000,0xb5edb544,0x354435ed,0x3544b5ed,0xb5ed3544
.long 0x00000000,0x00000000,0x00000000,0x00000000,0xb5d5b58e,0xb4c835fb,0x35fbb4c8,0xb58eb5d5
.long 0x00000000,0x00000000,0x00000000,0x00000000,0xb5b5b5b5,0xb5b535b5,0x35b535b5,0x35b5b5b5
.long 0x00000000,0x00000000,0x00000000,0x00000000,0xb58eb5d5,0xb5fb34c8,0xb4c835fb,0x35d5358e
.long 0x00000000,0x00000000,0x00000000,0x00000000,0xb544b5ed,0xb5edb544,0xb5ed3544,0xb54435ed
.long 0x00000000,0x00000000,0x00000000,0x00000000,0xb4c8b5fb,0xb58eb5d5,0xb5d5b58e,0xb5fbb4c8
.long 0x00000000,0x00000000,0x00000000,0x00000000,0xb6001c9f,0x36009db1,0xb6009d0d,0x36009dc2
.long 0x00000000,0x00000000,0x00000000,0x00000000,0x34c8b5fb,0xb58e35d5,0x35d5b58e,0xb5fb34c8
.long 0x00000000,0x00000000,0x00000000,0x00000000,0x35ed3544,0xb544b5ed,0xb54435ed,0x35edb544
.long 0x00000000,0x00000000,0x00000000,0x00000000,0xb58e35d5,0x35fb34c8,0xb4c8b5fb,0xb5d5358e
.long 0x00000000,0x00000000,0x00000000,0x00000000,0xb5b5b5b5,0xb5b535b5,0x35b535b5,0x35b5b5b5
.long 0x00000000,0x00000000,0x00000000,0x00000000,0x35d5b58e,0xb4c8b5fb,0xb5fbb4c8,0xb58e35d5
.long 0x00000000,0x00000000,0x00000000,0x00000000,0x354435ed,0x35ed3544,0x35edb544,0x3544b5ed
.long 0x00000000,0x00000000,0x00000000,0x00000000,0xb5fb34c8,0xb5d5358e,0xb58e35d5,0xb4c835fb
.long 0x80003600,0x80003600,0x80003600,0x80003600,0x36000000,0x36000000,0x36000000,0x36000000
.long 0x80003600,0xb54435ed,0xb5b535b5,0xb5ed3544,0x36000000,0x35ed3544,0x35b535b5,0x354435ed
.long 0x80003600,0xb5b535b5,0xb6001b0d,0xb5b5b5b5,0x36000000,0x35b535b5,0x1b0d3600,0xb5b535b5
.long 0x80003600,0xb5ed3544,0xb5b5b5b5,0x3544b5ed,0x36000000,0x354435ed,0xb5b535b5,0xb5edb544
.long 0x80003600,0xb6001b0d,0x9b8db600,0x36009bd4,0x36000000,0x1b0d3600,0xb6001b8d,0x9bd4b600
.long 0x80003600,0xb5edb544,0x35b5b5b5,0x354435ed,0x36000000,0xb54435ed,0xb5b5b5b5,0x35edb544
.long 0x80003600,0xb5b5b5b5,0x36009bd4,0xb5b535b5,0x36000000,0xb5b535b5,0x9bd4b600,0x35b535b5
.long 0x80003600,0xb544b5ed,0x35b535b5,0xb5edb544,0x36000000,0xb5ed3544,0x35b5b5b5,0xb54435ed
.long 0x80003600,0x80003600,0x80003600,0x80003600,0x36000000,0x36000000,0x36000000,0x36000000
.long 0xb6001b0d,0xb5edb544,0xb5b5b5b5,0xb544b5ed,0x1b0d3600,0xb54435ed,0xb5b535b5,0xb5ed3544
.long 0x9b8db600,0x35b5b5b5,0x36009bd4,0x35b535b5,0xb6001b8d,0xb5b5b5b5,0x9bd4b600,0x35b5b5b5
.long 0x36009bd4,0x354435ed,0xb5b535b5,0xb5edb544,0x9bd4b600,0x35edb544,0x35b535b5,0xb54435ed
.long 0x1c0d3600,0xb6001c30,0x9c54b600,0x36009c77,0x36009c0d,0x1c303600,0xb6001c54,0x9c77b600
.long 0xb6001c30,0x3544b5ed,0x35b535b5,0xb5ed3544,0x1c303600,0xb5edb544,0x35b5b5b5,0x354435ed
.long 0x9c54b600,0x35b535b5,0xb6001c9f,0x35b5b5b5,0xb6001c54,0x35b5b5b5,0x1c9f3600,0xb5b5b5b5
.long 0x36009c77,0xb5ed3544,0x35b5b5b5,0xb54435ed,0x9c77b600,0x354435ed,0xb5b5b5b5,0x35ed3544
.long 0x00003600,0x00003600,0x00003600,0x00003600,0xb6000000,0xb6000000,0xb6000000,0xb6000000
.long 0x1b8db600,0xb544b5ed,0xb5b5b5b5,0xb5edb544,0x36001b8d,0x35edb544,0x35b5b5b5,0x3544b5ed
.long 0x9c0d3600,0x35b535b5,0x36001c30,0x35b5b5b5,0xb6009c0d,0xb5b535b5,0x9c303600,0x35b535b5
.long 0x1c54b600,0xb5edb544,0xb5b535b5,0x354435ed,0x36001c54,0x3544b5ed,0xb5b5b5b5,0xb5ed3544
.long 0x9c8d3600,0x36001c9f,0x1cb0b600,0xb6009db1,0xb6009c8d,0x9c9f3600,0x36001cb0,0x1db1b600
.long 0x1cb0b600,0xb5ed3544,0x35b535b5,0x3544b5ed,0x36001cb0,0xb544b5ed,0xb5b535b5,0x35ed3544
.long 0x9cd43600,0x35b5b5b5,0xb6009dc2,0x35b535b5,0xb6009cd4,0x35b535b5,0x1dc2b600,0xb5b535b5
.long 0x1cf7b600,0xb54435ed,0x35b5b5b5,0xb5ed3544,0x36001cf7,0xb5edb544,0x35b535b5,0xb544b5ed
.long 0x00003600,0x00003600,0x00003600,0x00003600,0xb6000000,0xb6000000,0xb6000000,0xb6000000
.long 0xb6009bd4,0xb5ed3544,0xb5b535b5,0xb54435ed,0x1bd4b600,0xb544b5ed,0xb5b5b5b5,0xb5edb544
.long 0x1c54b600,0xb5b5b5b5,0xb6009c77,0xb5b535b5,0x36001c54,0x35b5b5b5,0x1c77b600,0xb5b5b5b5
.long 0x36001c9f,0x3544b5ed,0xb5b5b5b5,0xb5ed3544,0x9c9f3600,0x35ed3544,0x35b5b5b5,0xb544b5ed
.long 0x9cd43600,0x36009d0d,0x1cf7b600,0xb6009dc2,0xb6009cd4,0x1d0d3600,0x36001cf7,0x1dc2b600
.long 0xb6009dc2,0x354435ed,0x35b5b5b5,0xb5edb544,0x1dc2b600,0xb5ed3544,0x35b535b5,0x3544b5ed
.long 0x1d1fb600,0xb5b535b5,0x36009c8d,0xb5b5b5b5,0x36001d1f,0xb5b5b5b5,0x1c8d3600,0x35b5b5b5
.long 0x36009c8d,0xb5edb544,0x35b535b5,0xb544b5ed,0x1c8d3600,0x3544b5ed,0xb5b535b5,0x35edb544
.long 0x80003600,0x9b8db600,0x1c0d3600,0x9c54b600,0x36000000,0xb6001b8d,0x36009c0d,0xb6001c54
.long 0x80003600,0x3544b5ed,0xb5b535b5,0x35edb544,0x36000000,0xb5edb544,0x35b535b5,0xb544b5ed
.long 0x80003600,0x35b5b5b5,0xb6001c30,0x35b535b5,0x36000000,0xb5b5b5b5,0x1c303600,0x35b5b5b5
.long 0x80003600,0x35edb544,0xb5b5b5b5,0xb54435ed,0x36000000,0xb544b5ed,0xb5b535b5,0x35ed3544
.long 0x80003600,0x36009bd4,0x9c54b600,0xb6001c9f,0x36000000,0x9bd4b600,0xb6001c54,0x1c9f3600
.long 0x80003600,0x35ed3544,0x35b5b5b5,0xb544b5ed,0x36000000,0x3544b5ed,0xb5b5b5b5,0xb5ed3544
.long 0x80003600,0x35b535b5,0x36009c77,0x35b5b5b5,0x36000000,0x35b5b5b5,0x9c77b600,0xb5b5b5b5
.long 0x80003600,0x354435ed,0x35b535b5,0x35ed3544,0x36000000,0x35edb544,0x35b5b5b5,0x3544b5ed
.long 0x1c8d3600,0x9cb0b600,0x1cd43600,0x9cf7b600,0x36009c8d,0xb6001cb0,0x36009cd4,0xb6001cf7
.long 0xb6001c9f,0x35ed3544,0xb5b5b5b5,0x354435ed,0x1c9f3600,0x3544b5ed,0xb5b535b5,0x35edb544
.long 0x9cb0b600,0xb5b535b5,0x36009dc2,0xb5b5b5b5,0xb6001cb0,0x35b535b5,0x9dc2b600,0xb5b535b5
.long 0x36009db1,0xb544b5ed,0xb5b535b5,0x35ed3544,0x9db1b600,0xb5ed3544,0x35b535b5,0x3544b5ed
.long 0x1cd43600,0x36009dc2,0x9d1fb600,0xb6009c8d,0x36009cd4,0x9dc2b600,0xb6001d1f,0x9c8d3600
.long 0xb6009d0d,0xb54435ed,0x35b535b5,0x35edb544,0x9d0d3600,0x35ed3544,0x35b5b5b5,0xb544b5ed
.long 0x9cf7b600,0xb5b5b5b5,0xb6009c8d,0xb5b535b5,0xb6001cf7,0xb5b535b5,0x9c8d3600,0x35b535b5
.long 0x36009dc2,0x35edb544,0x35b5b5b5,0x3544b5ed,0x9dc2b600,0xb544b5ed,0xb5b5b5b5,0xb5edb544
.long 0x9d0d3600,0x1d1fb600,0x9d303600,0x1e31b600,0xb6009d0d,0x36001d1f,0xb6009d30,0x36001e31
.long 0x1d1fb600,0x354435ed,0xb5b5b5b5,0x35ed3544,0x36001d1f,0xb5ed3544,0x35b5b5b5,0xb54435ed
.long 0x9d303600,0xb5b5b5b5,0x36009c0e,0xb5b535b5,0xb6009d30,0x35b5b5b5,0x1c0e3600,0xb5b5b5b5
.long 0x1e31b600,0x35ed3544,0xb5b535b5,0xb544b5ed,0x36001e31,0xb54435ed,0xb5b5b5b5,0x35edb544
.long 0x9d543600,0xb6009df7,0x1e42b600,0x36001c0d,0xb6009d54,0x1df7b600,0x36001e42,0x9c0d3600
.long 0x9d8db600,0x35edb544,0x35b535b5,0xb54435ed,0x36009d8d,0x354435ed,0xb5b535b5,0xb5edb544
.long 0x9d773600,0xb5b535b5,0xb6009e0d,0xb5b5b5b5,0xb6009d77,0xb5b5b5b5,0x1e0db600,0x35b5b5b5
.long 0x1e42b600,0x3544b5ed,0x35b5b5b5,0x35edb544,0x36001e42,0x35ed3544,0x35b535b5,0x354435ed
.long 0x9d543600,0x9d8db600,0x9d773600,0x1e42b600,0xb6009d54,0x36009d8d,0xb6009d77,0x36001e42
.long 0xb6009df7,0x35edb544,0xb5b535b5,0x3544b5ed,0x1df7b600,0x354435ed,0xb5b5b5b5,0x35ed3544
.long 0x1e42b600,0x35b535b5,0xb6009e0d,0x35b5b5b5,0x36001e42,0xb5b535b5,0x1e0db600,0x35b535b5
.long 0x36001e84,0xb54435ed,0xb5b5b5b5,0x35edb544,0x9e843600,0xb5edb544,0x35b5b5b5,0x354435ed
.long 0x9d9f3600,0xb6009e16,0x9d0db600,0x36001d0d,0xb6009d9f,0x1e16b600,0x36009d0d,0x9d0d3600
.long 0xb6001dd4,0xb544b5ed,0x35b5b5b5,0x35ed3544,0x9dd4b600,0x35edb544,0x35b535b5,0xb54435ed
.long 0x9d0db600,0x35b5b5b5,0x36001e96,0x35b535b5,0x36009d0d,0x35b535b5,0x9e963600,0xb5b535b5
.long 0x36001f09,0x35ed3544,0x35b535b5,0x354435ed,0x9f093600,0xb54435ed,0xb5b535b5,0xb5ed3544
.size L_tables, 8192
L_tables_end:
.p2align 8
.type L_stab,@object
L_stab:
.set id_, 0
.rept 256
.set w_, 0
.set q_, 2*(id_&1)+((id_>>3)&1)
.set s2_, ((id_>>1)&3)+4*(id_>>4)
.set tq_, 2*(id_&1)
.set tn_, 176
.rept 4
.set u2_, (((id_>=192) & (2*(id_-192)+(w_>>1))) | (~(id_>=192) & (((((id_>=8)&(id_<56)&(w_<2)) & (120+id_)) | (~((id_>=8)&(id_<56)&(w_<2)) & (999))))))
.long (((id_>>4)*128+(id_&7)*4+32*w_)*514)
.long (60672+w_*4128)
.long ((id_>>4)*128+(id_&7)*4)
.long ((((q_==0)&(w_==0)) & (1)) | (~((q_==0)&(w_==0)) & ((((((id_>=64)&(id_<192))&(w_==1)) & (2)) | (~(((id_>=64)&(id_<192))&(w_==1)) & (((((((id_>>3)&1)==0)&(w_==2)) & (3)) | (~((((id_>>3)&1)==0)&(w_==2)) & (0)))))))))
.long ((8*((id_>>3)&1)+w_)*32)
.long (6291456+((id_&7)<<18)+((id_>>4)<<8)+(((id_>>3)&1)<<13)+(w_<<6))
.long (65536+w_*2048)
.long (52224+(w_>>1)*2112+(w_&1)*64)
.long (2097152+(s2_<<15)+(q_<<10)+(w_<<8))
.long ((((id_>=64)&(w_==0)) & (196608+(id_-64)*16)) | (~((id_>=64)&(w_==0)) & (2147483392)))
.long (((((id_>=64)&(id_<192))) & ((id_&3)*786432+(id_>>2)*128)) | (~(((id_>=64)&(id_<192))) & (2147483392)))
.long (((((id_>=64)&(id_<192))) & ((id_&3)*256)) | (~(((id_>=64)&(id_<192))) & (2147483392)))
.long ((id_&3)*12288+(id_>>2)*256)
.long (6291456+((id_&7)<<18)+((id_>>4)<<8))
.long (131072+((id_&7)<<10)+((id_>>4)<<6))
.long 0
.long ((((u2_<176)) & (((u2_>>2)<<15)+((u2_&1)<<14)+(((u2_>>1)&1)<<11))) | (~((u2_<176)) & (2147483392)))
.long ((((u2_<176)) & (8388608+((((u2_>>2)/11)*352+2*(((((u2_>>2)-11*((u2_>>2)/11))>=8) & (((u2_>>2)-11*((u2_>>2)/11))-8)) | (~(((u2_>>2)-11*((u2_>>2)/11))>=8) & (((u2_>>2)-11*((u2_>>2)/11))+3)))+((u2_>>1)&1))<<10)+((u2_&1)<<9))) | (~((u2_<176)) & (2147483392)))
.long ((q_*11+w_)<<15)
.long (((w_==3) & (2147483392)) | (~(w_==3) & (((q_*11+w_)+8)<<15)))
.long (60672+(w_<<15))
.long (((w_==3) & (262144+id_*32)) | (~(w_==3) & (2147483392)))
.long (2097152+(((id_&7)<<12)+((id_>>3)<<7)+((w_>>1)<<6))+((w_&1)<<20))
.long (2097152+(((id_&7)<<12)+((id_>>3)<<7)+((w_>>1)<<6))+((1-(w_&1))<<20))
.long (4194304+(((id_&7)<<12)+((id_>>3)<<7)+((w_>>1)<<6))+((w_&1)<<20))
.long (6291456+((id_&7)<<18)+((id_>>3)<<13)+((w_>>1)<<12)+((w_&1)<<11))
.long ((id_>>3)|(w_>>1))
.long (w_*2048+4096)
.long (393216+((id_&7)<<8)+((w_&1)<<16))
.long (393216+((id_&7)<<8)+((1-(w_&1))<<16))
.long (131072+((id_&7)<<10)+((w_&1)<<9))
.long (tq_*360448+(id_>>3)*tn_*128)
.long (60672+(w_<<15))
.long (60672+(w_<<11))
.long (((w_==3) & (158976)) | (~(w_==3) & (60672+(w_<<11)+16384)))
.long (58560+(4*q_+w_)*8)
.long ((s2_<<10)+((4*q_+w_)<<6))
.long (278528+(4*s2_+q_)*128+w_*8)
.long (278528+s2_*512+w_*8)
.long (52224+w_*528)
.long 0, 0, 0, 0, 0, 0, 0, 0
.long (52224+(((w_==0) & (2)) | (~(w_==0) & ((((w_==3) & (3)) | (~(w_==3) & (w_-1))))))*2112)
.long (((w_==2) & (1065353216)) | (~(w_==2) & (0)))
.long (((w_==0) & (1065353216)) | (~(w_==0) & ((((w_==3) & (1060205080)) | (~(w_==3) & (1069066811))))))
.long (4194304+(s2_<<15)+(w_<<10))
.long (tq_*360448+((id_>>3)*4+w_)*tn_*32)
.long (((q_*11+w_)+8)*64)
.long ((q_*11+w_)*64)
.long (((q_*11+w_)+4)*64)
.long (10485760+(4*s2_+(q_^2))*24576+(w_<<11))
.long (10493952+(4*s2_+(q_^3))*24576+(w_<<11))
.long (10502144+(4*s2_+(q_^1))*24576+(w_<<11))
.long (10485760+(4*s2_+q_)*24576+(w_<<11))
.long (q_*360448+((q_^2)*4+w_)*22528)
.long (q_*360448+((q_^3)*4+w_)*22528)
.long (q_*360448+((q_^1)*4+w_)*22528)
.long (q_*360448+((q_^0)*4+w_)*22528)
.set w_, w_+1
.endr
.set id_, id_+1
.endr
.size L_stab, 262144
```
